```python
import torch

def _softmax(x, axis=-1):
    return torch.softmax(x, dim=axis)
def _gelu(x):
    return torch.nn.functional.gelu(x, approximate="tanh")
def _silu(x):
    return torch.nn.functional.silu(x)
def _sigmoid(x):
    return torch.sigmoid(x)
def _layernorm(x, axis=-1, eps=1e-5):
    m = x.mean(dim=axis, keepdim=True)
    v = x.var(dim=axis, keepdim=True, unbiased=False)
    return (x - m) / torch.sqrt(v + eps)
def _scatter_add(tgt, idx, src, axis=0):
    return tgt.clone().index_add_(axis, idx, src)
def _segment_sum(src, seg, n):
    out = torch.zeros((n,) + src.shape[1:], dtype=src.dtype)
    return out.index_add_(0, seg, src)
def _pad(x, pw):
    flat = tuple(v for pair in reversed(pw) for v in pair)
    return torch.nn.functional.pad(x, flat)

kernel_name = 'standalone__grouped__vision'

def setup_inputs():

    _w = (lambda a: (lambda t: t.to(torch.bfloat16) if t.is_floating_point() else t)(torch.as_tensor(a)))
    H = W = 224
    G = 4
    Cg = max(96 // G, 2)
    C = G * Cg
    k = 7
    scale = 1.0 / (k * Cg ** 0.5)
    return {
        "x": _w((lambda *s: torch.randn(*s, dtype=torch.bfloat16) * 0.05)(1, H, W, C)),
        "w": _w((lambda *s: torch.randn(*s, dtype=torch.bfloat16) * 0.05)(k, k, G, Cg, Cg) * scale),
    }

def reference(x, w):
    B, H, W, C = x.shape
    k = w.shape[0]
    G = w.shape[2]
    Cg = C // G
    pad = k // 2
    xp = _pad(x, ((0,0),(pad,pad),(pad,pad),(0,0)))
    xg = xp.reshape(B, H + 2 * pad, W + 2 * pad, G, Cg)
    out = torch.zeros_like(x).reshape(B, H, W, G, Cg)
    for i in range(k):
        for j in range(k):
            out = out + torch.einsum('bhwgc,gcd->bhwgd', xg[:, i:i+H, j:j+W, :, :], w[i, j])
    return out.reshape(B, H, W, C)
```

```asm
; @launch grid=(256,1,1) block=(256,1,1) lds=149152
.amdgcn_target "amdgcn-amd-amdhsa--gfx950"
.text
.globl standalone__grouped__vision_kernel
.p2align 12
.fill 640, 4, 0xbf800000
.p2align 8
.type standalone__grouped__vision_kernel,@function
standalone__grouped__vision_kernel:
    s_load_dwordx2 s[16:17], s[0:1], 8
    s_load_dwordx2 s[12:13], s[0:1], 0
    s_load_dwordx2 s[20:21], s[0:1], 16
    s_cmp_ge_u32 s2, 256
    s_cbranch_scc1 L_end
    v_lshrrev_b32 v4, 6, v0
    v_and_b32 v1, 63, v0
    v_readfirstlane_b32 s27, v4
    s_getpc_b64 s[4:5]
L_pc:
    s_lshr_b32 s6, s2, 3
    v_lshl_add_u32 v5, s6, 2, v4
    v_lshlrev_b32 v5, 7, v5
    v_min_u32 v5, L_end-L_pc-128, v5
    global_load_dword v47, v5, s[4:5] offset:128
    s_and_b32 s32, s2, 7
    s_mul_i32 s25, s32, 28
    s_bfe_u32 s24, s2, 0x20003
    s_lshr_b32 s32, s2, 5
    s_mul_i32 s26, s32, 28
    s_mov_b32 s14, 9633792
    s_mov_b32 s15, 0x20000
    s_mov_b32 s18, 225792
    s_mov_b32 s19, 0x20000
    s_mov_b32 s22, 9633792
    s_mov_b32 s23, 0x20000
    s_movk_i32 s36, 224
    s_add_i32 s33, s26, -3
    s_mul_i32 s34, s33, 192
    s_mul_i32 s35, s24, 48
    s_add_i32 s34, s34, s35
    v_bfrev_b32 v8, 1
    v_mul_u32_u24 v5, 171, v1
    v_lshrrev_b32 v5, 9, v5
    v_add_u32 v6, s33, v5
    v_cmp_gt_u32 vcc, s36, v6
    v_mul_u32_u24 v7, 144, v5
    v_lshl_add_u32 v7, v1, 4, v7
    v_add_u32 v7, s34, v7
    v_cndmask_b32 v19, v8, v7, vcc
    v_add_u32 v4, 60, v1
    v_mul_u32_u24 v5, 171, v4
    v_lshrrev_b32 v5, 9, v5
    v_add_u32 v6, s33, v5
    v_cmp_gt_u32 vcc, s36, v6
    v_mul_u32_u24 v7, 144, v5
    v_lshl_add_u32 v7, v4, 4, v7
    v_add_u32 v7, s34, v7
    s_and_b32 vcc_hi, vcc_hi, 1023
    v_cndmask_b32 v20, v8, v7, vcc
    s_bitcmp1_b32 s27, 0
    s_cselect_b64 vcc, -1, 0
    s_cselect_b32 s43, 960, 0
    v_cndmask_b32 v16, v19, v20, vcc
    s_add_i32 s37, s25, -3
    s_mul_i32 s37, s37, 43008
    s_lshr_b32 s42, s27, 1
    s_mul_i32 s35, s42, 344064
    s_add_i32 s52, s37, s35
    s_mul_i32 s53, s42, 16512
    s_add_u32 s53, s53, s43
    s_mul_i32 s35, s27, 43008
    s_add_i32 s58, s37, s35
    s_mul_i32 s59, s27, 2064
    s_waitcnt lgkmcnt(0)
    s_add_u32 m0, s53, 12384
    s_add_i32 s3, s52, 258048
    buffer_load_dwordx4 v16, s[12:15], s3 offen nt lds
    s_add_u32 m0, s59, 44304
    s_add_i32 s3, s58, 903168
    buffer_load_dwordx4 v20, s[12:15], s3 offen nt lds
    s_add_u32 m0, s53, 14448
    s_add_i32 s3, s52, 301056
    buffer_load_dwordx4 v16, s[12:15], s3 offen nt lds
    s_lshr_b32 s32, s2, 5
    s_lshl_b32 s32, s32, 3
    s_and_b32 s33, s24, 1
    s_lshl_b32 s33, s33, 2
    s_add_u32 s32, s32, s33
    s_add_u32 s32, s32, s27
    s_mul_i32 s32, s32, 12
    s_add_u32 s32, s32, 0
    s_add_u32 s33, s24, 1
    s_bitcmp1_b32 s33, 1
    s_cselect_b32 vcc_lo, 0, 0xfff
    s_mov_b32 vcc_hi, 0
    v_bfrev_b32 v10, 1
    v_add_lshl_u32 v11, s32, v1, 7
    v_cndmask_b32 v25, v10, v11, vcc
    buffer_load_dword v47, v25, s[16:19], 0 offen
    s_lshr_b32 s32, s2, 5
    s_lshl_b32 s32, s32, 3
    s_and_b32 s33, s24, 1
    s_lshl_b32 s33, s33, 2
    s_add_u32 s32, s32, s33
    s_add_u32 s32, s32, s27
    s_mul_i32 s32, s32, 16
    s_add_u32 s32, s32, 756
    s_add_u32 s33, s24, 1
    s_bitcmp1_b32 s33, 1
    s_cselect_b32 vcc_lo, 0, 0xffff
    s_mov_b32 vcc_hi, 0
    v_bfrev_b32 v10, 1
    v_add_lshl_u32 v11, s32, v1, 7
    v_cndmask_b32 v46, v10, v11, vcc
    s_mul_i32 s38, s24, 1152
    s_lshl_b32 s28, s27, 10
    s_add_u32 s28, s28, 70176
    s_mov_b32 s39, 0x122001
    s_mov_b32 s40, 0x24180c00
    s_mov_b32 s41, 0x25190d01
    s_cmp_ge_u32 s27, 3
    s_cselect_b32 s40, 0x261a0e02, s40
    s_cselect_b32 s41, 0x3d313c30, s41
    v_mul_u32_u24 v4, 0x556, v0
    v_lshrrev_b32 v4, 16, v4
    v_mul_u32_u24 v5, 48, v4
    v_sub_u32 v5, v0, v5
    v_lshrrev_b32 v6, 3, v5
    v_lshrrev_b32 v7, v6, 52
    v_lshlrev_b32 v6, 2, v6
    v_bfe_u32 v17, s39, v6, 2
    v_and_b32 v7, 1, v7
    v_bfe_u32 v6, v5, 2, 1
    v_lshl_add_u32 v7, v7, 1, v6
    v_and_b32 v8, 2, v4
    v_lshl_add_u32 v7, v8, 1, v7
    v_lshlrev_b32 v7, 3, v7
    v_cmp_eq_u32 vcc, 10, v4
    v_and_b32 v4, 1, v4
    v_and_b32 v5, 3, v5
    v_cndmask_b32 v4, v4, v6, vcc
    v_lshl_add_u32 v4, v4, 2, v5
    v_lshrrev_b64 v[6:7], v7, s[40:41]
    v_lshlrev_b32 v17, 4, v17
    v_mad_u32_u24 v17, v4, 48, v17
    v_and_b32 v6, 0xff, v6
    v_mul_u32_u24 v6, 384, v6
    v_add3_u32 v17, v17, v6, s38
    s_mov_b32 s40, 0x261a0e02
    s_mov_b32 s41, 0x3d313c30
    s_cmp_ge_u32 s27, 2
    s_cselect_b32 s40, 0x49483e32, s40
    s_cselect_b32 s41, 0x4a4a4a4a, s41
    v_add_u32 v9, 0x100, v0
    v_mul_u32_u24 v4, 0x556, v9
    v_lshrrev_b32 v4, 16, v4
    v_mul_u32_u24 v5, 48, v4
    v_sub_u32 v5, v9, v5
    v_lshrrev_b32 v6, 3, v5
    v_lshrrev_b32 v7, v6, 52
    v_lshlrev_b32 v6, 2, v6
    v_bfe_u32 v18, s39, v6, 2
    v_and_b32 v7, 1, v7
    v_bfe_u32 v6, v5, 2, 1
    v_lshl_add_u32 v7, v7, 1, v6
    v_and_b32 v8, 2, v4
    v_lshl_add_u32 v7, v8, 1, v7
    v_lshlrev_b32 v7, 3, v7
    v_cmp_eq_u32 vcc, 10, v4
    v_and_b32 v4, 1, v4
    v_and_b32 v5, 3, v5
    v_cndmask_b32 v4, v4, v6, vcc
    v_lshl_add_u32 v4, v4, 2, v5
    v_lshrrev_b64 v[6:7], v7, s[40:41]
    v_lshlrev_b32 v18, 4, v18
    v_mad_u32_u24 v18, v4, 48, v18
    v_and_b32 v6, 0xff, v6
    v_mul_u32_u24 v6, 384, v6
    v_add3_u32 v18, v18, v6, s38
    s_add_u32 m0, s28, 8320
    s_mov_b32 s10, 0
    buffer_load_dwordx4 v17, s[16:19], s10 offen  lds
    s_add_u32 m0, s28, 12416
    s_nop 0
    buffer_load_dwordx4 v18, s[16:19], s10 offen  lds
    s_add_u32 m0, s28, 16640
    s_mov_b32 s10, 32256
    buffer_load_dwordx4 v17, s[16:19], s10 offen  lds
    s_add_u32 m0, s28, 20736
    s_nop 0
    buffer_load_dwordx4 v18, s[16:19], s10 offen  lds
    s_mul_i32 s35, s42, 43008
    s_add_i32 s54, s37, s35
    s_mul_i32 s55, s42, 2064
    s_add_u32 s55, s55, s43
    s_mul_i32 s35, s42, 1419264
    s_add_i32 s56, s37, s35
    s_mul_i32 s57, s42, 68112
    s_add_u32 s57, s57, s43
    v_mov_b32 v96, 0
    v_mov_b32 v97, 0
    v_mov_b32 v98, 0
    v_mov_b32 v99, 0
    v_lshlrev_b32 v4, 4, v0
    v_add_u32 v4, 70176, v4
    v_add_u32 v5, 66560, v4
    ds_write_b128 v4, v[96:99] offset:0
    ds_write_b128 v4, v[96:99] offset:4096
    ds_write_b128 v5, v[96:99] offset:0
    ds_write_b128 v5, v[96:99] offset:4096
    v_lshrrev_b32 v2, 4, v1
    v_bfe_u32 v4, v1, 2, 2
    v_and_b32 v5, 1, v1
    v_bfe_u32 v6, v1, 1, 1
    v_lshlrev_b32 v4, 4, v4
    v_mul_u32_u24 v7, 8320, v6
    v_mul_u32_u24 v8, 8320, v2
    s_mov_b32 s32, 0x45523001
    v_and_b32 v9, 3, v1
    v_lshlrev_b32 v9, 2, v9
    v_bfe_u32 v23, s32, v9, 4
    v_lshrrev_b32 v22, 5, v1
    v_lshl_add_u32 v9, v22, 4, v9
    v_bfe_u32 v21, s32, v9, 4
    v_lshl_add_u32 v9, v5, 3, v4
    v_lshl_add_u32 v23, v23, 7, v9
    v_add_u32 v23, v23, v8
    v_add_u32 v23, 77856, v23
    v_lshl_add_u32 v21, v21, 7, v9
    v_and_b32 v9, 16, v1
    v_lshlrev_b32 v9, 2, v9
    v_add_u32 v21, v21, v9
    v_add_u32 v21, 78496, v21
    v_mul_u32_u24 v5, 248, v5
    v_add_u32 v4, v4, v5
    v_sub_u32 v4, v4, v7
    v_add_u32 v24, v4, v8
    v_add_u32 v24, 86312, v24
    v_lshl_add_u32 v22, v22, 7, v4
    v_add_u32 v22, v22, v9
    v_add_u32 v22, 78632, v22
    v_lshlrev_b32 v14, 3, v2
    s_mov_b32 s32, 0x100d0f0c
    s_mov_b32 s33, 0x1312110e
    v_bfe_u32 v11, s32, v14, 8
    v_bfe_u32 v12, s33, v14, 8
    v_lshlrev_b32 v11, 4, v11
    v_lshlrev_b32 v12, 4, v12
    v_mul_u32_u24 v10, 48, v2
    v_mul_u32_u24 v13, 2064, v2
    v_add_u32 v13, 320, v13
    s_mov_b32 s34, 0x3020100
    s_cmp_eq_u32 s27, 1
    s_cselect_b32 s34, 0x26060504, s34
    s_cmp_eq_u32 s27, 2
    s_cselect_b32 s34, 0x13121110, s34
    s_cmp_eq_u32 s27, 3
    s_cselect_b32 s34, 0x25161514, s34
    v_lshlrev_b32 v4, 1, v1
    v_and_b32 v4, 24, v4
    v_bfe_u32 v4, s34, v4, 8
    v_lshrrev_b32 v5, 3, v4
    v_and_b32 v4, 7, v4
    v_and_b32 v6, 3, v1
    v_lshl_add_u32 v4, v4, 2, v6
    v_mul_u32_u24 v6, 8256, v5
    v_mad_u32_u24 v6, v4, 48, v6
    v_add_u32 v26, v6, v10
    v_add_u32 v27, v6, v11
    v_add_u32 v28, v6, v12
    v_add_u32 v29, v6, v13
    v_mul_u32_u24 v7, 172032, v5
    v_mul_u32_u24 v4, 192, v4
    v_add_u32 v31, v7, v4
    s_lshr_b32 s11, s2, 3
    s_xor_b32 s32, s27, 3
    s_or_b32 s11, s11, s32
    buffer_load_dword v47, v46, s[16:19], 0 offen
    s_waitcnt lgkmcnt(0)
    s_mov_b64 exec, 0
    s_cmp_eq_u32 s27, 0
    s_cbranch_scc1 L_stub0
    s_cmp_eq_u32 s27, 1
    s_cbranch_scc1 L_stub1
    s_cmp_eq_u32 s27, 2
    s_cbranch_scc1 L_stub2
    s_cmp_eq_u32 s27, 3
    s_cbranch_scc1 L_stub3
L_back:
    s_mov_b64 exec, -1
    s_waitcnt vmcnt(8)
    s_barrier
    s_add_u32 m0, s28, 24960
    s_mov_b32 s10, 64512
    buffer_load_dwordx4 v17, s[16:19], s10 offen  lds
    s_add_u32 m0, s28, 29056
    s_nop 0
    buffer_load_dwordx4 v18, s[16:19], s10 offen  lds
    s_waitcnt vmcnt(9)
    s_barrier
    ds_read_b128 v[96:99], v26 offset:12384
    ds_read_b128 v[100:103], v26 offset:12400
    ds_read_b128 v[104:107], v26 offset:12416
    s_add_u32 m0, s28, 33280
    s_mov_b32 s10, 96768
    buffer_load_dwordx4 v17, s[16:19], s10 offen  lds
    s_add_u32 m0, s28, 37376
    s_nop 0
    buffer_load_dwordx4 v18, s[16:19], s10 offen  lds
    ds_read_b128 v[108:111], v27 offset:12384
    ds_read_b128 v[112:115], v28 offset:12384
    s_waitcnt vmcnt(10)
    s_barrier
    ds_read_b128 v[116:119], v26 offset:14448
    ds_read_b128 v[120:123], v26 offset:14464
    ds_read_b128 v[124:127], v26 offset:14480
    s_add_u32 m0, s28, 41600
    s_mov_b32 s10, 129024
    buffer_load_dwordx4 v17, s[16:19], s10 offen  lds
    s_add_u32 m0, s28, 45696
    s_nop 0
    buffer_load_dwordx4 v18, s[16:19], s10 offen  lds
    ds_read_b128 v[128:131], v27 offset:14448
    ds_read_b128 v[132:135], v28 offset:14448
    s_waitcnt vmcnt(9)
    s_barrier
    ds_read_b64_tr_b16 a[0:1], v21 offset:0
    ds_read_b64_tr_b16 a[2:3], v21 offset:768
    ds_read_b64_tr_b16 a[140:141], v22 offset:0
    ds_read_b64_tr_b16 a[142:143], v22 offset:768
    ds_read_b64_tr_b16 a[4:5], v21 offset:1536
    ds_read_b64_tr_b16 a[6:7], v21 offset:2304
    ds_read_b64_tr_b16 a[144:145], v22 offset:1536
    ds_read_b64_tr_b16 a[146:147], v22 offset:2304
    ds_read_b64_tr_b16 a[8:9], v21 offset:3072
    ds_read_b64_tr_b16 a[10:11], v21 offset:3840
    ds_read_b64_tr_b16 a[148:149], v22 offset:3072
    ds_read_b64_tr_b16 a[150:151], v22 offset:3840
    ds_read_b64_tr_b16 a[12:13], v21 offset:4608
    ds_read_b64_tr_b16 a[14:15], v21 offset:5376
    s_waitcnt lgkmcnt(12)
    v_mfma_f32_16x16x32_bf16 v[84:87], a[0:3], v[96:99], 0
    s_add_u32 m0, s28, 49920
    ds_read_b64_tr_b16 a[152:153], v22 offset:4608
    s_mov_b32 s10, 161280
    v_mfma_f32_16x16x32_bf16 v[88:91], a[0:3], v[116:119], 0
    s_waitcnt lgkmcnt(11)
    buffer_load_dwordx4 v17, s[16:19], s10 offen  lds
    ds_read_b64_tr_b16 a[154:155], v22 offset:5376
    v_mfma_f32_16x16x32_bf16 v[92:95], a[140:143], v[96:99], 0
    s_waitcnt lgkmcnt(10)
    ds_read_b64_tr_b16 a[16:17], v21 offset:6144
    s_add_u32 m0, s28, 54016
    v_mfma_f32_16x16x32_bf16 v[84:87], a[4:7], v[100:103], v[84:87]
    buffer_load_dwordx4 v18, s[16:19], s10 offen  lds
    ds_read_b64_tr_b16 a[18:19], v21 offset:6912
    v_mfma_f32_16x16x32_bf16 v[88:91], a[4:7], v[120:123], v[88:91]
    s_waitcnt lgkmcnt(10)
    s_waitcnt vmcnt(9)
    s_barrier
    ds_read_b64_tr_b16 a[156:157], v22 offset:6144
    v_mfma_f32_16x16x32_bf16 v[92:95], a[144:147], v[100:103], v[92:95]
    s_waitcnt lgkmcnt(9)
    ds_read_b64_tr_b16 a[158:159], v22 offset:6912
    ds_read_b64_tr_b16 a[20:21], v21 offset:8320
    v_mfma_f32_16x16x32_bf16 v[84:87], a[8:11], v[104:107], v[84:87]
    s_add_u32 m0, s28, 58240
    ds_read_b64_tr_b16 a[22:23], v21 offset:9088
    ds_read_b64_tr_b16 a[160:161], v22 offset:8320
    v_mfma_f32_16x16x32_bf16 v[88:91], a[8:11], v[124:127], v[88:91]
    s_waitcnt lgkmcnt(11)
    ds_read_b64_tr_b16 a[162:163], v22 offset:9088
    ds_read_b64_tr_b16 a[24:25], v21 offset:9856
    v_mfma_f32_16x16x32_bf16 v[92:95], a[148:151], v[104:107], v[92:95]
    s_waitcnt lgkmcnt(11)
    ds_read_b64_tr_b16 a[26:27], v21 offset:10624
    ds_read_b64_tr_b16 a[164:165], v22 offset:9856
    v_mfma_f32_16x16x32_bf16 v[84:87], a[12:15], v[108:111], v[84:87]
    s_mov_b32 s10, 193536
    buffer_load_dwordx4 v17, s[16:19], s10 offen  lds
    ds_read_b64_tr_b16 a[166:167], v22 offset:10624
    v_mfma_f32_16x16x32_bf16 v[88:91], a[12:15], v[128:131], v[88:91]
    s_waitcnt lgkmcnt(11)
    ds_read_b64_tr_b16 a[28:29], v21 offset:11392
    ds_read_b64_tr_b16 a[30:31], v21 offset:12160
    v_mfma_f32_16x16x32_bf16 v[92:95], a[152:155], v[108:111], v[92:95]
    s_waitcnt lgkmcnt(12)
    ds_read_b64_tr_b16 a[168:169], v22 offset:11392
    s_add_u32 m0, s28, 62336
    v_mfma_f32_16x16x32_bf16 v[84:87], a[16:19], v[112:115], v[84:87]
    buffer_load_dwordx4 v18, s[16:19], s10 offen  lds
    ds_read_b64_tr_b16 a[170:171], v22 offset:12160
    v_mfma_f32_16x16x32_bf16 v[88:91], a[16:19], v[132:135], v[88:91]
    s_waitcnt lgkmcnt(11)
    ds_read_b64_tr_b16 a[32:33], v21 offset:12928
    v_mfma_f32_16x16x32_bf16 v[92:95], a[156:159], v[112:115], v[92:95]
    s_waitcnt lgkmcnt(11)
    ds_read_b64_tr_b16 a[34:35], v21 offset:13696
    v_mfma_f32_16x16x32_bf16 v[52:55], a[20:23], v[96:99], 0
    ds_read_b64_tr_b16 a[172:173], v22 offset:12928
    v_mfma_f32_16x16x32_bf16 v[84:87], a[20:23], v[116:119], v[84:87]
    s_waitcnt lgkmcnt(10)
    ds_read_b64_tr_b16 a[174:175], v22 offset:13696
    v_mfma_f32_16x16x32_bf16 v[92:95], a[160:163], v[116:119], v[92:95]
    s_waitcnt lgkmcnt(9)
    ds_read_b64_tr_b16 a[36:37], v21 offset:14464
    v_mfma_f32_16x16x32_bf16 v[52:55], a[24:27], v[100:103], v[52:55]
    ds_read_b64_tr_b16 a[38:39], v21 offset:15232
    v_mfma_f32_16x16x32_bf16 v[84:87], a[24:27], v[120:123], v[84:87]
    s_waitcnt lgkmcnt(9)
    ds_read_b64_tr_b16 a[176:177], v22 offset:14464
    v_mfma_f32_16x16x32_bf16 v[92:95], a[164:167], v[120:123], v[92:95]
    s_waitcnt lgkmcnt(8)
    ds_read_b64_tr_b16 a[178:179], v22 offset:15232
    v_mfma_f32_16x16x32_bf16 v[52:55], a[28:31], v[104:107], v[52:55]
    v_mfma_f32_16x16x32_bf16 v[84:87], a[28:31], v[124:127], v[84:87]
    s_waitcnt lgkmcnt(8)
    s_waitcnt vmcnt(8)
    s_barrier
    ds_read_b64_tr_b16 a[40:41], v21 offset:16640
    v_mfma_f32_16x16x32_bf16 v[92:95], a[168:171], v[124:127], v[92:95]
    s_waitcnt lgkmcnt(7)
    ds_read_b64_tr_b16 a[42:43], v21 offset:17408
    ds_read_b64_tr_b16 a[180:181], v22 offset:16640
    v_mfma_f32_16x16x32_bf16 v[52:55], a[32:35], v[108:111], v[52:55]
    s_add_u32 m0, s53, 10320
    ds_read_b64_tr_b16 a[182:183], v22 offset:17408
    ds_read_b64_tr_b16 a[44:45], v21 offset:18176
    v_mfma_f32_16x16x32_bf16 v[84:87], a[32:35], v[128:131], v[84:87]
    s_waitcnt lgkmcnt(9)
    ds_read_b64_tr_b16 a[46:47], v21 offset:18944
    ds_read_b64_tr_b16 a[184:185], v22 offset:18176
    v_mfma_f32_16x16x32_bf16 v[92:95], a[172:175], v[128:131], v[92:95]
    s_waitcnt lgkmcnt(9)
    ds_read_b64_tr_b16 a[186:187], v22 offset:18944
    ds_read_b64_tr_b16 a[48:49], v21 offset:19712
    v_mfma_f32_16x16x32_bf16 v[52:55], a[36:39], v[112:115], v[52:55]
    s_add_i32 s3, s52, 215040
    buffer_load_dwordx4 v16, s[12:15], s3 offen nt lds
    ds_read_b64_tr_b16 a[50:51], v21 offset:20480
    v_mfma_f32_16x16x32_bf16 v[84:87], a[36:39], v[132:135], v[84:87]
    s_waitcnt lgkmcnt(10)
    ds_read_b64_tr_b16 a[188:189], v22 offset:19712
    ds_read_b64_tr_b16 a[190:191], v22 offset:20480
    v_mfma_f32_16x16x32_bf16 v[92:95], a[176:179], v[132:135], v[92:95]
    s_waitcnt lgkmcnt(10)
    ds_read_b64_tr_b16 a[52:53], v21 offset:21248
    ds_read_b64_tr_b16 a[54:55], v21 offset:22016
    v_mfma_f32_16x16x32_bf16 v[48:51], a[40:43], v[96:99], 0
    ds_read_b64_tr_b16 a[192:193], v22 offset:21248
    v_mfma_f32_16x16x32_bf16 v[52:55], a[40:43], v[116:119], v[52:55]
    s_waitcnt lgkmcnt(11)
    ds_read_b64_tr_b16 a[194:195], v22 offset:22016
    v_mfma_f32_16x16x32_bf16 v[56:59], a[180:183], v[96:99], 0
    s_waitcnt lgkmcnt(10)
    ds_read_b64_tr_b16 a[56:57], v21 offset:22784
    v_mfma_f32_16x16x32_bf16 v[48:51], a[44:47], v[100:103], v[48:51]
    ds_read_b64_tr_b16 a[58:59], v21 offset:23552
    v_mfma_f32_16x16x32_bf16 v[52:55], a[44:47], v[120:123], v[52:55]
    s_waitcnt lgkmcnt(10)
    ds_read_b64_tr_b16 a[196:197], v22 offset:22784
    v_mfma_f32_16x16x32_bf16 v[56:59], a[184:187], v[100:103], v[56:59]
    s_waitcnt lgkmcnt(9)
    s_waitcnt vmcnt(7)
    s_barrier
    ds_read_b64_tr_b16 a[198:199], v22 offset:23552
    v_mfma_f32_16x16x32_bf16 v[48:51], a[48:51], v[104:107], v[48:51]
    s_add_u32 m0, s53, 16512
    ds_read_b64_tr_b16 a[60:61], v21 offset:24960
    ds_read_b64_tr_b16 a[62:63], v21 offset:25728
    v_mfma_f32_16x16x32_bf16 v[52:55], a[48:51], v[124:127], v[52:55]
    s_waitcnt lgkmcnt(10)
    ds_read_b64_tr_b16 a[200:201], v22 offset:24960
    ds_read_b64_tr_b16 a[202:203], v22 offset:25728
    v_mfma_f32_16x16x32_bf16 v[56:59], a[188:191], v[104:107], v[56:59]
    s_waitcnt lgkmcnt(10)
    ds_read_b64_tr_b16 a[64:65], v21 offset:26496
    ds_read_b64_tr_b16 a[66:67], v21 offset:27264
    v_mfma_f32_16x16x32_bf16 v[48:51], a[52:55], v[108:111], v[48:51]
    s_add_i32 s3, s52, 344064
    buffer_load_dwordx4 v16, s[12:15], s3 offen nt lds
    ds_read_b64_tr_b16 a[204:205], v22 offset:26496
    v_mfma_f32_16x16x32_bf16 v[52:55], a[52:55], v[128:131], v[52:55]
    s_waitcnt lgkmcnt(10)
    ds_read_b64_tr_b16 a[206:207], v22 offset:27264
    ds_read_b64_tr_b16 a[68:69], v21 offset:28032
    v_mfma_f32_16x16x32_bf16 v[56:59], a[192:195], v[108:111], v[56:59]
    s_waitcnt lgkmcnt(11)
    ds_read_b64_tr_b16 a[70:71], v21 offset:28800
    ds_read_b64_tr_b16 a[208:209], v22 offset:28032
    v_mfma_f32_16x16x32_bf16 v[48:51], a[56:59], v[112:115], v[48:51]
    ds_read_b64_tr_b16 a[210:211], v22 offset:28800
    v_mfma_f32_16x16x32_bf16 v[52:55], a[56:59], v[132:135], v[52:55]
    s_waitcnt lgkmcnt(12)
    ds_read_b64_tr_b16 a[72:73], v21 offset:29568
    v_mfma_f32_16x16x32_bf16 v[56:59], a[196:199], v[112:115], v[56:59]
    s_waitcnt lgkmcnt(11)
    ds_read_b64_tr_b16 a[74:75], v21 offset:30336
    v_mfma_f32_16x16x32_bf16 v[60:63], a[60:63], v[96:99], 0
    ds_read_b64_tr_b16 a[212:213], v22 offset:29568
    v_mfma_f32_16x16x32_bf16 v[48:51], a[60:63], v[116:119], v[48:51]
    s_waitcnt lgkmcnt(11)
    s_waitcnt vmcnt(6)
    s_barrier
    ds_read_b64_tr_b16 a[214:215], v22 offset:30336
    v_mfma_f32_16x16x32_bf16 v[56:59], a[200:203], v[116:119], v[56:59]
    s_waitcnt lgkmcnt(10)
    ds_read_b64_tr_b16 a[76:77], v21 offset:31104
    ds_read_b64_tr_b16 a[78:79], v21 offset:31872
    v_mfma_f32_16x16x32_bf16 v[60:63], a[64:67], v[100:103], v[60:63]
    ds_read_b64_tr_b16 a[216:217], v22 offset:31104
    ds_read_b64_tr_b16 a[218:219], v22 offset:31872
    v_mfma_f32_16x16x32_bf16 v[48:51], a[64:67], v[120:123], v[48:51]
    s_waitcnt lgkmcnt(11)
    ds_read_b64_tr_b16 a[80:81], v21 offset:33280
    ds_read_b64_tr_b16 a[82:83], v21 offset:34048
    v_mfma_f32_16x16x32_bf16 v[56:59], a[204:207], v[120:123], v[56:59]
    s_waitcnt lgkmcnt(11)
    ds_read_b64_tr_b16 a[220:221], v22 offset:33280
    ds_read_b64_tr_b16 a[222:223], v22 offset:34048
    v_mfma_f32_16x16x32_bf16 v[60:63], a[68:71], v[104:107], v[60:63]
    ds_read_b64_tr_b16 a[84:85], v21 offset:34816
    ds_read_b64_tr_b16 a[86:87], v21 offset:35584
    v_mfma_f32_16x16x32_bf16 v[48:51], a[68:71], v[124:127], v[48:51]
    s_waitcnt lgkmcnt(12)
    ds_read_b64_tr_b16 a[224:225], v22 offset:34816
    v_mfma_f32_16x16x32_bf16 v[56:59], a[208:211], v[124:127], v[56:59]
    ds_read_b64_tr_b16 a[226:227], v22 offset:35584
    v_mfma_f32_16x16x32_bf16 v[60:63], a[72:75], v[108:111], v[60:63]
    ds_read_b64_tr_b16 a[88:89], v21 offset:36352
    v_mfma_f32_16x16x32_bf16 v[48:51], a[72:75], v[128:131], v[48:51]
    s_waitcnt lgkmcnt(12)
    ds_read_b64_tr_b16 a[90:91], v21 offset:37120
    v_mfma_f32_16x16x32_bf16 v[56:59], a[212:215], v[128:131], v[56:59]
    s_waitcnt lgkmcnt(12)
    ds_read_b64_tr_b16 a[228:229], v22 offset:36352
    v_mfma_f32_16x16x32_bf16 v[60:63], a[76:79], v[112:115], v[60:63]
    s_waitcnt vmcnt(4)
    s_barrier
    ds_read_b64_tr_b16 a[230:231], v22 offset:37120
    v_mfma_f32_16x16x32_bf16 v[48:51], a[76:79], v[132:135], v[48:51]
    s_waitcnt lgkmcnt(10)
    ds_read_b64_tr_b16 a[92:93], v21 offset:37888
    ds_read_b64_tr_b16 a[94:95], v21 offset:38656
    v_mfma_f32_16x16x32_bf16 v[56:59], a[216:219], v[132:135], v[56:59]
    ds_read_b64_tr_b16 a[232:233], v22 offset:37888
    ds_read_b64_tr_b16 a[234:235], v22 offset:38656
    v_mfma_f32_16x16x32_bf16 v[64:67], a[80:83], v[96:99], 0
    ds_read_b64_tr_b16 a[96:97], v21 offset:39424
    ds_read_b64_tr_b16 a[98:99], v21 offset:40192
    v_mfma_f32_16x16x32_bf16 v[60:63], a[80:83], v[116:119], v[60:63]
    s_waitcnt lgkmcnt(11)
    ds_read_b64_tr_b16 a[236:237], v22 offset:39424
    ds_read_b64_tr_b16 a[238:239], v22 offset:40192
    v_mfma_f32_16x16x32_bf16 v[68:71], a[220:223], v[96:99], 0
    ds_read_b64_tr_b16 a[100:101], v21 offset:41600
    ds_read_b64_tr_b16 a[102:103], v21 offset:42368
    v_mfma_f32_16x16x32_bf16 v[64:67], a[84:87], v[100:103], v[64:67]
    ds_read_b64_tr_b16 a[240:241], v22 offset:41600
    v_mfma_f32_16x16x32_bf16 v[60:63], a[84:87], v[120:123], v[60:63]
    s_waitcnt lgkmcnt(12)
    ds_read_b64_tr_b16 a[242:243], v22 offset:42368
    v_mfma_f32_16x16x32_bf16 v[68:71], a[224:227], v[100:103], v[68:71]
    ds_read_b64_tr_b16 a[104:105], v21 offset:43136
    v_mfma_f32_16x16x32_bf16 v[64:67], a[88:91], v[104:107], v[64:67]
    ds_read_b64_tr_b16 a[106:107], v21 offset:43904
    v_mfma_f32_16x16x32_bf16 v[60:63], a[88:91], v[124:127], v[60:63]
    s_waitcnt lgkmcnt(12)
    ds_read_b64_tr_b16 a[244:245], v22 offset:43136
    v_mfma_f32_16x16x32_bf16 v[68:71], a[228:231], v[104:107], v[68:71]
    s_waitcnt vmcnt(2)
    s_barrier
    ds_read_b64_tr_b16 a[246:247], v22 offset:43904
    v_mfma_f32_16x16x32_bf16 v[64:67], a[92:95], v[108:111], v[64:67]
    ds_read_b64_tr_b16 a[108:109], v21 offset:44672
    ds_read_b64_tr_b16 a[110:111], v21 offset:45440
    v_mfma_f32_16x16x32_bf16 v[60:63], a[92:95], v[128:131], v[60:63]
    s_waitcnt lgkmcnt(10)
    ds_read_b64_tr_b16 a[248:249], v22 offset:44672
    ds_read_b64_tr_b16 a[250:251], v22 offset:45440
    v_mfma_f32_16x16x32_bf16 v[68:71], a[232:235], v[108:111], v[68:71]
    ds_read_b64_tr_b16 a[112:113], v21 offset:46208
    ds_read_b64_tr_b16 a[114:115], v21 offset:46976
    v_mfma_f32_16x16x32_bf16 v[64:67], a[96:99], v[112:115], v[64:67]
    ds_read_b64_tr_b16 a[252:253], v22 offset:46208
    ds_read_b64_tr_b16 a[254:255], v22 offset:46976
    v_mfma_f32_16x16x32_bf16 v[60:63], a[96:99], v[132:135], v[60:63]
    ds_read_b64_tr_b16 a[116:117], v21 offset:47744
    ds_read_b64_tr_b16 a[118:119], v21 offset:48512
    v_mfma_f32_16x16x32_bf16 v[68:71], a[236:239], v[112:115], v[68:71]
    s_waitcnt lgkmcnt(12)
    ds_read_b64_tr_b16 v[188:189], v22 offset:47744
    ds_read_b64_tr_b16 v[190:191], v22 offset:48512
    v_mfma_f32_16x16x32_bf16 v[72:75], a[100:103], v[96:99], 0
    s_add_u32 m0, s53, 8256
    ds_read_b64_tr_b16 a[120:121], v21 offset:49920
    ds_read_b64_tr_b16 a[122:123], v21 offset:50688
    v_mfma_f32_16x16x32_bf16 v[64:67], a[100:103], v[116:119], v[64:67]
    s_add_i32 s3, s52, 172032
    buffer_load_dwordx4 v16, s[12:15], s3 offen nt lds
    ds_read_b64_tr_b16 v[192:193], v22 offset:49920
    v_mfma_f32_16x16x32_bf16 v[68:71], a[240:243], v[116:119], v[68:71]
    ds_read_b64_tr_b16 v[194:195], v22 offset:50688
    ds_read_b64_tr_b16 v[212:213], v22 offset:58240
    v_mfma_f32_16x16x32_bf16 v[72:75], a[104:107], v[100:103], v[72:75]
    ds_read_b64_tr_b16 v[214:215], v22 offset:59008
    ds_read_b64_tr_b16 a[124:125], v21 offset:51456
    v_mfma_f32_16x16x32_bf16 v[64:67], a[104:107], v[120:123], v[64:67]
    s_waitcnt lgkmcnt(13)
    ds_read_b64_tr_b16 a[126:127], v21 offset:52224
    ds_read_b64_tr_b16 v[196:197], v22 offset:51456
    v_mfma_f32_16x16x32_bf16 v[68:71], a[244:247], v[120:123], v[68:71]
    ds_read_b64_tr_b16 v[198:199], v22 offset:52224
    v_mfma_f32_16x16x32_bf16 v[72:75], a[108:111], v[104:107], v[72:75]
    ds_read_b64_tr_b16 v[216:217], v22 offset:59776
    v_mfma_f32_16x16x32_bf16 v[64:67], a[108:111], v[124:127], v[64:67]
    ds_read_b64_tr_b16 v[218:219], v22 offset:60544
    v_mfma_f32_16x16x32_bf16 v[68:71], a[248:251], v[124:127], v[68:71]
    ds_read_b64_tr_b16 a[128:129], v21 offset:52992
    v_mfma_f32_16x16x32_bf16 v[72:75], a[112:115], v[108:111], v[72:75]
    ds_read_b64_tr_b16 a[130:131], v21 offset:53760
    v_mfma_f32_16x16x32_bf16 v[64:67], a[112:115], v[128:131], v[64:67]
    s_waitcnt lgkmcnt(11)
    ds_read_b64_tr_b16 v[200:201], v22 offset:52992
    v_mfma_f32_16x16x32_bf16 v[68:71], a[252:255], v[128:131], v[68:71]
    ds_read_b64_tr_b16 v[202:203], v22 offset:53760
    v_mfma_f32_16x16x32_bf16 v[72:75], a[116:119], v[112:115], v[72:75]
    s_add_u32 m0, s55, 39216
    ds_read_b64_tr_b16 v[220:221], v22 offset:61312
    s_add_i32 s3, s54, 817152
    v_mfma_f32_16x16x32_bf16 v[64:67], a[116:119], v[132:135], v[64:67]
    buffer_load_dwordx4 v16, s[12:15], s3 offen nt lds
    ds_read_b64_tr_b16 v[222:223], v22 offset:62080
    v_mfma_f32_16x16x32_bf16 v[68:71], v[188:191], v[132:135], v[68:71]
    ds_read_b64_tr_b16 a[132:133], v21 offset:54528
    v_mfma_f32_16x16x32_bf16 v[76:79], a[120:123], v[96:99], 0
    ds_read_b64_tr_b16 a[134:135], v21 offset:55296
    v_mfma_f32_16x16x32_bf16 v[72:75], a[120:123], v[116:119], v[72:75]
    s_waitcnt lgkmcnt(8)
    ds_read_b64_tr_b16 v[204:205], v22 offset:54528
    v_mfma_f32_16x16x32_bf16 v[80:83], v[192:195], v[96:99], 0
    ds_read_b64_tr_b16 v[206:207], v22 offset:55296
    v_mfma_f32_16x16x32_bf16 v[80:83], v[212:215], v[116:119], v[80:83]
    ds_read_b64_tr_b16 v[224:225], v22 offset:62848
    v_mfma_f32_16x16x32_bf16 v[76:79], a[124:127], v[100:103], v[76:79]
    ds_read_b64_tr_b16 v[226:227], v22 offset:63616
    v_mfma_f32_16x16x32_bf16 v[72:75], a[124:127], v[120:123], v[72:75]
    ds_read_b64_tr_b16 a[136:137], v21 offset:56064
    v_mfma_f32_16x16x32_bf16 v[80:83], v[196:199], v[100:103], v[80:83]
    ds_read_b64_tr_b16 a[138:139], v21 offset:56832
    v_mfma_f32_16x16x32_bf16 v[80:83], v[216:219], v[120:123], v[80:83]
    s_waitcnt lgkmcnt(9)
    s_waitcnt vmcnt(3)
    s_barrier
    ds_read_b64_tr_b16 v[208:209], v22 offset:56064
    v_mfma_f32_16x16x32_bf16 v[76:79], a[128:131], v[104:107], v[76:79]
    ds_read_b64_tr_b16 v[210:211], v22 offset:56832
    v_mfma_f32_16x16x32_bf16 v[72:75], a[128:131], v[124:127], v[72:75]
    ds_read_b64_tr_b16 v[228:229], v22 offset:64384
    v_mfma_f32_16x16x32_bf16 v[80:83], v[200:203], v[104:107], v[80:83]
    s_waitcnt lgkmcnt(8)
    ds_read_b64_tr_b16 v[230:231], v22 offset:65152
    v_mfma_f32_16x16x32_bf16 v[80:83], v[220:223], v[124:127], v[80:83]
    ds_read_b128 v[136:139], v26 offset:10320
    v_mfma_f32_16x16x32_bf16 v[76:79], a[132:135], v[108:111], v[76:79]
    ds_read_b128 v[140:143], v26 offset:10336
    s_add_u32 m0, s53, 18576
    v_mfma_f32_16x16x32_bf16 v[72:75], a[132:135], v[128:131], v[72:75]
    s_waitcnt lgkmcnt(8)
    ds_read_b128 v[144:147], v26 offset:10352
    s_add_i32 s3, s52, 387072
    v_mfma_f32_16x16x32_bf16 v[80:83], v[204:207], v[108:111], v[80:83]
    buffer_load_dwordx4 v16, s[12:15], s3 offen nt lds
    ds_read_b128 v[148:151], v27 offset:10320
    v_mfma_f32_16x16x32_bf16 v[80:83], v[224:227], v[128:131], v[80:83]
    s_waitcnt lgkmcnt(8)
    ds_read_b128 v[152:155], v28 offset:10320
    v_mfma_f32_16x16x32_bf16 v[76:79], a[136:139], v[112:115], v[76:79]
    ds_read_b64_tr_b16 v[236:237], v23 offset:41600
    v_mfma_f32_16x16x32_bf16 v[72:75], a[136:139], v[132:135], v[72:75]
    s_waitcnt lgkmcnt(8)
    ds_read_b64_tr_b16 v[238:239], v23 offset:41664
    v_mfma_f32_16x16x32_bf16 v[80:83], v[208:211], v[112:115], v[80:83]
    s_waitcnt lgkmcnt(7)
    ds_read_b64_tr_b16 v[244:245], v23 offset:33280
    v_mfma_f32_16x16x32_bf16 v[80:83], v[228:231], v[132:135], v[80:83]
    s_waitcnt lgkmcnt(7)
    ds_read_b64_tr_b16 v[246:247], v23 offset:33344
    v_mfma_f32_16x16x32_bf16 v[76:79], a[100:103], v[136:139], v[76:79]
    s_waitcnt lgkmcnt(7)
    ds_read_b64_tr_b16 v[252:253], v24 offset:33280
    v_mfma_f32_16x16x32_bf16 v[76:79], a[104:107], v[140:143], v[76:79]
    s_waitcnt lgkmcnt(7)
    ds_read_b64_tr_b16 v[254:255], v24 offset:33344
    v_mfma_f32_16x16x32_bf16 v[76:79], a[108:111], v[144:147], v[76:79]
    s_waitcnt lgkmcnt(7)
    ds_read_b64_tr_b16 v[232:233], v23 offset:8320
    v_mfma_f32_16x16x32_bf16 v[76:79], a[112:115], v[148:151], v[76:79]
    s_waitcnt lgkmcnt(7)
    ds_read_b64_tr_b16 v[234:235], v23 offset:8384
    v_mfma_f32_16x16x32_bf16 v[76:79], a[116:119], v[152:155], v[76:79]
    ds_read_b64_tr_b16 v[240:241], v23 offset:0
    v_mfma_f32_16x16x32_bf16 v[72:75], a[80:83], v[136:139], v[72:75]
    ds_read_b64_tr_b16 v[242:243], v23 offset:64
    v_mfma_f32_16x16x32_bf16 v[72:75], a[84:87], v[140:143], v[72:75]
    ds_read_b64_tr_b16 v[248:249], v24 offset:0
    v_mfma_f32_16x16x32_bf16 v[72:75], a[88:91], v[144:147], v[72:75]
    ds_read_b64_tr_b16 v[250:251], v24 offset:64
    s_add_u32 m0, s59, 52560
    v_mfma_f32_16x16x32_bf16 v[72:75], a[92:95], v[148:151], v[72:75]
    s_add_i32 s3, s58, 1075200
    buffer_load_dwordx4 v20, s[12:15], s3 offen nt lds
    v_mfma_f32_16x16x32_bf16 v[72:75], a[96:99], v[152:155], v[72:75]
    v_mfma_f32_16x16x32_bf16 v[64:67], a[60:63], v[136:139], v[64:67]
    v_mfma_f32_16x16x32_bf16 v[64:67], a[64:67], v[140:143], v[64:67]
    v_mfma_f32_16x16x32_bf16 v[64:67], a[68:71], v[144:147], v[64:67]
    v_mfma_f32_16x16x32_bf16 v[64:67], a[72:75], v[148:151], v[64:67]
    v_mfma_f32_16x16x32_bf16 v[64:67], a[76:79], v[152:155], v[64:67]
    v_mfma_f32_16x16x32_bf16 v[60:63], a[40:43], v[136:139], v[60:63]
    v_mfma_f32_16x16x32_bf16 v[60:63], a[44:47], v[140:143], v[60:63]
    v_mfma_f32_16x16x32_bf16 v[60:63], a[48:51], v[144:147], v[60:63]
    v_mfma_f32_16x16x32_bf16 v[60:63], a[52:55], v[148:151], v[60:63]
    v_mfma_f32_16x16x32_bf16 v[60:63], a[56:59], v[152:155], v[60:63]
    v_mfma_f32_16x16x32_bf16 v[48:51], a[20:23], v[136:139], v[48:51]
    v_mfma_f32_16x16x32_bf16 v[48:51], a[24:27], v[140:143], v[48:51]
    v_mfma_f32_16x16x32_bf16 v[48:51], a[28:31], v[144:147], v[48:51]
    v_mfma_f32_16x16x32_bf16 v[48:51], a[32:35], v[148:151], v[48:51]
    v_mfma_f32_16x16x32_bf16 v[48:51], a[36:39], v[152:155], v[48:51]
    s_add_u32 m0, s53, 6192
    s_add_i32 s3, s52, 129024
    v_mfma_f32_16x16x32_bf16 v[52:55], a[0:3], v[136:139], v[52:55]
    buffer_load_dwordx4 v16, s[12:15], s3 offen nt lds
    v_mfma_f32_16x16x32_bf16 v[52:55], a[4:7], v[140:143], v[52:55]
    v_mfma_f32_16x16x32_bf16 v[52:55], a[8:11], v[144:147], v[52:55]
    v_mfma_f32_16x16x32_bf16 v[52:55], a[12:15], v[148:151], v[52:55]
    s_waitcnt vmcnt(5)
    s_barrier
    ds_read_b128 v[156:159], v26 offset:16512
    v_mfma_f32_16x16x32_bf16 v[52:55], a[16:19], v[152:155], v[52:55]
    ds_read_b128 v[160:163], v26 offset:16528
    v_mfma_f32_16x16x32_bf16 v[80:83], a[240:243], v[136:139], v[80:83]
    ds_read_b128 v[164:167], v26 offset:16544
    v_mfma_f32_16x16x32_bf16 v[80:83], a[244:247], v[140:143], v[80:83]
    ds_read_b128 v[168:171], v27 offset:16512
    v_mfma_f32_16x16x32_bf16 v[80:83], a[248:251], v[144:147], v[80:83]
    ds_read_b128 v[172:175], v28 offset:16512
    v_mfma_f32_16x16x32_bf16 v[80:83], a[252:255], v[148:151], v[80:83]
    v_mfma_f32_16x16x32_bf16 v[80:83], v[188:191], v[152:155], v[80:83]
    v_mfma_f32_16x16x32_bf16 v[68:71], a[200:203], v[136:139], v[68:71]
    v_mfma_f32_16x16x32_bf16 v[68:71], a[204:207], v[140:143], v[68:71]
    v_mfma_f32_16x16x32_bf16 v[68:71], a[208:211], v[144:147], v[68:71]
    v_mfma_f32_16x16x32_bf16 v[68:71], a[212:215], v[148:151], v[68:71]
    v_mfma_f32_16x16x32_bf16 v[68:71], a[216:219], v[152:155], v[68:71]
    s_add_u32 m0, s53, 20640
    s_add_i32 s3, s52, 430080
    v_mfma_f32_16x16x32_bf16 v[56:59], a[160:163], v[136:139], v[56:59]
    buffer_load_dwordx4 v16, s[12:15], s3 offen nt lds
    v_mfma_f32_16x16x32_bf16 v[56:59], a[164:167], v[140:143], v[56:59]
    v_mfma_f32_16x16x32_bf16 v[56:59], a[168:171], v[144:147], v[56:59]
    v_mfma_f32_16x16x32_bf16 v[56:59], a[172:175], v[148:151], v[56:59]
    v_mfma_f32_16x16x32_bf16 v[56:59], a[176:179], v[152:155], v[56:59]
    s_waitcnt lgkmcnt(0)
    v_mfma_f32_16x16x32_bf16 v[64:67], a[120:123], v[156:159], v[64:67]
    v_mfma_f32_16x16x32_bf16 v[64:67], a[124:127], v[160:163], v[64:67]
    v_mfma_f32_16x16x32_bf16 v[64:67], a[128:131], v[164:167], v[64:67]
    v_mfma_f32_16x16x32_bf16 v[64:67], a[132:135], v[168:171], v[64:67]
    v_mfma_f32_16x16x32_bf16 v[64:67], a[136:139], v[172:175], v[64:67]
    v_mfma_f32_16x16x32_bf16 v[60:63], a[100:103], v[156:159], v[60:63]
    v_mfma_f32_16x16x32_bf16 v[60:63], a[104:107], v[160:163], v[60:63]
    v_mfma_f32_16x16x32_bf16 v[60:63], a[108:111], v[164:167], v[60:63]
    v_mfma_f32_16x16x32_bf16 v[60:63], a[112:115], v[168:171], v[60:63]
    v_mfma_f32_16x16x32_bf16 v[60:63], a[116:119], v[172:175], v[60:63]
    v_mfma_f32_16x16x32_bf16 v[48:51], a[80:83], v[156:159], v[48:51]
    s_add_u32 m0, s55, 2064
    s_add_i32 s3, s54, 43008
    v_mfma_f32_16x16x32_bf16 v[48:51], a[84:87], v[160:163], v[48:51]
    buffer_load_dwordx4 v16, s[12:15], s3 offen nt lds
    v_mfma_f32_16x16x32_bf16 v[48:51], a[88:91], v[164:167], v[48:51]
    v_mfma_f32_16x16x32_bf16 v[48:51], a[92:95], v[168:171], v[48:51]
    v_mfma_f32_16x16x32_bf16 v[48:51], a[96:99], v[172:175], v[48:51]
    v_lshrrev_b32 v4, 1, v2
    v_and_b32 v5, 1, v2
    v_mfma_f32_16x16x32_bf16 v[52:55], a[60:63], v[156:159], v[52:55]
    v_mul_u32_u24 v5, 24, v5
    v_mad_u32_u24 v15, v4, 12, v5
    v_mfma_f32_16x16x32_bf16 v[52:55], a[64:67], v[160:163], v[52:55]
    v_lshl_add_u32 v14, v4, 4, v5
    s_mov_b32 s8, -1
    v_mfma_f32_16x16x32_bf16 v[52:55], a[68:71], v[164:167], v[52:55]
    s_mov_b32 s9, 0
    s_mul_i32 s29, s25, 43008
    s_mul_i32 s37, s26, 192
    v_mfma_f32_16x16x32_bf16 v[52:55], a[72:75], v[168:171], v[52:55]
    s_add_u32 s29, s29, s37
    s_mul_i32 s37, s24, 48
    s_add_u32 s29, s29, s37
    v_mfma_f32_16x16x32_bf16 v[52:55], a[76:79], v[172:175], v[52:55]
    s_add_u32 s44, s29, 0
    s_add_u32 s45, s29, 43008
    s_add_u32 s46, s29, 86016
    v_mfma_f32_16x16x32_bf16 v[84:87], a[40:43], v[156:159], v[84:87]
    s_add_u32 s47, s29, 129024
    s_add_u32 s48, s29, 172032
    s_add_u32 s49, s29, 215040
    v_mfma_f32_16x16x32_bf16 v[84:87], a[44:47], v[160:163], v[84:87]
    s_add_u32 s50, s29, 258048
    s_add_u32 s51, s29, 301056
    v_add_u32 v30, v31, v15
    v_mfma_f32_16x16x32_bf16 v[84:87], a[48:51], v[164:167], v[84:87]
    v_mfma_f32_16x16x32_bf16 v[84:87], a[52:55], v[168:171], v[84:87]
    v_mfma_f32_16x16x32_bf16 v[84:87], a[56:59], v[172:175], v[84:87]
    v_mfma_f32_16x16x32_bf16 v[88:91], a[20:23], v[156:159], v[88:91]
    s_add_u32 m0, s57, 0
    s_add_i32 s3, s56, 0
    v_mfma_f32_16x16x32_bf16 v[88:91], a[24:27], v[160:163], v[88:91]
    buffer_load_dwordx4 v16, s[12:15], s3 offen nt lds
    v_mfma_f32_16x16x32_bf16 v[88:91], a[28:31], v[164:167], v[88:91]
    v_mfma_f32_16x16x32_bf16 v[88:91], a[32:35], v[168:171], v[88:91]
    s_waitcnt vmcnt(6)
    s_barrier
    ds_read_b128 v[176:179], v29 offset:8256
    v_mfma_f32_16x16x32_bf16 v[88:91], a[36:39], v[172:175], v[88:91]
    ds_read_b128 v[180:183], v26 offset:8256
    v_mfma_f32_16x16x32_bf16 v[68:71], v[192:195], v[156:159], v[68:71]
    ds_read_b128 v[184:187], v26 offset:8272
    v_mfma_f32_16x16x32_bf16 v[68:71], v[196:199], v[160:163], v[68:71]
    ds_read_b128 v[96:99], v26 offset:8288
    v_mfma_f32_16x16x32_bf16 v[68:71], v[200:203], v[164:167], v[68:71]
    ds_read_b128 v[116:119], v27 offset:8256
    v_mfma_f32_16x16x32_bf16 v[68:71], v[204:207], v[168:171], v[68:71]
    ds_read_b128 v[100:103], v28 offset:8256
    v_mfma_f32_16x16x32_bf16 v[68:71], v[208:211], v[172:175], v[68:71]
    v_mfma_f32_16x16x32_bf16 v[56:59], a[220:223], v[156:159], v[56:59]
    v_mfma_f32_16x16x32_bf16 v[56:59], a[224:227], v[160:163], v[56:59]
    v_mfma_f32_16x16x32_bf16 v[56:59], a[228:231], v[164:167], v[56:59]
    v_mfma_f32_16x16x32_bf16 v[56:59], a[232:235], v[168:171], v[56:59]
    v_mfma_f32_16x16x32_bf16 v[56:59], a[236:239], v[172:175], v[56:59]
    v_mfma_f32_16x16x32_bf16 v[92:95], a[180:183], v[156:159], v[92:95]
    v_mfma_f32_16x16x32_bf16 v[92:95], a[184:187], v[160:163], v[92:95]
L_stub0:
    s_cbranch_execz L_stub4
    s_add_u32 m0, s59, 43344
    s_add_i32 s3, s58, 903168
    v_mfma_f32_16x16x32_bf16 v[92:95], a[188:191], v[164:167], v[92:95]
    buffer_load_dwordx4 v19, s[12:15], s3 offen nt lds
    v_mfma_f32_16x16x32_bf16 v[92:95], a[192:195], v[168:171], v[92:95]
    v_mfma_f32_16x16x32_bf16 v[92:95], a[196:199], v[172:175], v[92:95]
    s_waitcnt lgkmcnt(0)
    v_mfma_f32_16x16x32_bf16 v[76:79], v[236:239], v[176:179], v[76:79]
    v_mfma_f32_16x16x32_bf16 v[72:75], v[244:247], v[176:179], v[72:75]
    v_mfma_f32_16x16x32_bf16 v[80:83], v[252:255], v[176:179], v[80:83]
    v_mfma_f32_16x16x32_bf16 v[48:51], v[232:235], v[176:179], v[48:51]
    v_mfma_f32_16x16x32_bf16 v[52:55], v[240:243], v[176:179], v[52:55]
    v_mfma_f32_16x16x32_bf16 v[56:59], v[248:251], v[176:179], v[56:59]
    v_mfma_f32_16x16x32_bf16 v[76:79], a[80:83], v[180:183], v[76:79]
    v_mfma_f32_16x16x32_bf16 v[76:79], a[84:87], v[184:187], v[76:79]
    v_mfma_f32_16x16x32_bf16 v[76:79], a[88:91], v[96:99], v[76:79]
    v_mfma_f32_16x16x32_bf16 v[76:79], a[92:95], v[116:119], v[76:79]
    v_mfma_f32_16x16x32_bf16 v[76:79], a[96:99], v[100:103], v[76:79]
    v_mfma_f32_16x16x32_bf16 v[72:75], a[60:63], v[180:183], v[72:75]
    v_mfma_f32_16x16x32_bf16 v[72:75], a[64:67], v[184:187], v[72:75]
    s_add_u32 m0, s59, 60816
    s_add_i32 s3, s58, 1247232
    v_mfma_f32_16x16x32_bf16 v[72:75], a[68:71], v[96:99], v[72:75]
    buffer_load_dwordx4 v20, s[12:15], s3 offen nt lds
    v_mfma_f32_16x16x32_bf16 v[72:75], a[72:75], v[116:119], v[72:75]
    v_mfma_f32_16x16x32_bf16 v[72:75], a[76:79], v[100:103], v[72:75]
    v_mfma_f32_16x16x32_bf16 v[64:67], a[40:43], v[180:183], v[64:67]
    v_mfma_f32_16x16x32_bf16 v[64:67], a[44:47], v[184:187], v[64:67]
    v_mfma_f32_16x16x32_bf16 v[64:67], a[48:51], v[96:99], v[64:67]
    v_mfma_f32_16x16x32_bf16 v[64:67], a[52:55], v[116:119], v[64:67]
    v_mfma_f32_16x16x32_bf16 v[64:67], a[56:59], v[100:103], v[64:67]
    v_mfma_f32_16x16x32_bf16 v[60:63], a[20:23], v[180:183], v[60:63]
    v_mfma_f32_16x16x32_bf16 v[60:63], a[24:27], v[184:187], v[60:63]
    v_mfma_f32_16x16x32_bf16 v[60:63], a[28:31], v[96:99], v[60:63]
    v_mfma_f32_16x16x32_bf16 v[60:63], a[32:35], v[116:119], v[60:63]
    v_mfma_f32_16x16x32_bf16 v[60:63], a[36:39], v[100:103], v[60:63]
    v_mfma_f32_16x16x32_bf16 v[48:51], a[0:3], v[180:183], v[48:51]
    v_mfma_f32_16x16x32_bf16 v[48:51], a[4:7], v[184:187], v[48:51]
    s_add_u32 m0, s59, 51600
    s_add_i32 s3, s58, 1075200
    v_mfma_f32_16x16x32_bf16 v[48:51], a[8:11], v[96:99], v[48:51]
    buffer_load_dwordx4 v19, s[12:15], s3 offen nt lds
    v_mfma_f32_16x16x32_bf16 v[48:51], a[12:15], v[116:119], v[48:51]
    s_waitcnt vmcnt(7)
    s_barrier
    ds_read_b128 v[120:123], v29 offset:12384
    v_mfma_f32_16x16x32_bf16 v[48:51], a[16:19], v[100:103], v[48:51]
    ds_read_b128 v[104:107], v26 offset:18576
    v_mfma_f32_16x16x32_bf16 v[80:83], a[220:223], v[180:183], v[80:83]
    ds_read_b128 v[124:127], v26 offset:18592
    v_mfma_f32_16x16x32_bf16 v[80:83], a[224:227], v[184:187], v[80:83]
    ds_read_b128 v[108:111], v26 offset:18608
    v_mfma_f32_16x16x32_bf16 v[80:83], a[228:231], v[96:99], v[80:83]
    ds_read_b128 v[128:131], v27 offset:18576
    v_mfma_f32_16x16x32_bf16 v[80:83], a[232:235], v[116:119], v[80:83]
    ds_read_b128 v[112:115], v28 offset:18576
    v_mfma_f32_16x16x32_bf16 v[80:83], a[236:239], v[100:103], v[80:83]
    v_mfma_f32_16x16x32_bf16 v[68:71], a[180:183], v[180:183], v[68:71]
    v_mfma_f32_16x16x32_bf16 v[68:71], a[184:187], v[184:187], v[68:71]
    v_mfma_f32_16x16x32_bf16 v[68:71], a[188:191], v[96:99], v[68:71]
    v_mfma_f32_16x16x32_bf16 v[68:71], a[192:195], v[116:119], v[68:71]
    v_mfma_f32_16x16x32_bf16 v[68:71], a[196:199], v[100:103], v[68:71]
    v_mfma_f32_16x16x32_bf16 v[56:59], a[140:143], v[180:183], v[56:59]
    v_mfma_f32_16x16x32_bf16 v[56:59], a[144:147], v[184:187], v[56:59]
    v_mfma_f32_16x16x32_bf16 v[56:59], a[148:151], v[96:99], v[56:59]
    s_add_u32 m0, s59, 59856
    s_add_i32 s3, s58, 1247232
    v_mfma_f32_16x16x32_bf16 v[56:59], a[152:155], v[116:119], v[56:59]
    buffer_load_dwordx4 v19, s[12:15], s3 offen nt lds
    v_mfma_f32_16x16x32_bf16 v[56:59], a[156:159], v[100:103], v[56:59]
    s_waitcnt lgkmcnt(0)
    v_mfma_f32_16x16x32_bf16 v[64:67], v[236:239], v[120:123], v[64:67]
    v_mfma_f32_16x16x32_bf16 v[60:63], v[244:247], v[120:123], v[60:63]
    v_mfma_f32_16x16x32_bf16 v[68:71], v[252:255], v[120:123], v[68:71]
    v_mfma_f32_16x16x32_bf16 v[84:87], v[232:235], v[120:123], v[84:87]
    v_mfma_f32_16x16x32_bf16 v[88:91], v[240:243], v[120:123], v[88:91]
    v_mfma_f32_16x16x32_bf16 v[92:95], v[248:251], v[120:123], v[92:95]
    ds_read_b128 v[132:135], v26 offset:24768
    v_mfma_f32_16x16x32_bf16 v[60:63], a[120:123], v[104:107], v[60:63]
    ds_read_b128 v[136:139], v26 offset:24784
    v_mfma_f32_16x16x32_bf16 v[60:63], a[124:127], v[124:127], v[60:63]
    ds_read_b128 v[140:143], v26 offset:24800
    v_mfma_f32_16x16x32_bf16 v[60:63], a[128:131], v[108:111], v[60:63]
    ds_read_b128 v[144:147], v27 offset:24768
    v_mfma_f32_16x16x32_bf16 v[60:63], a[132:135], v[128:131], v[60:63]
    ds_read_b128 v[148:151], v28 offset:24768
    v_mfma_f32_16x16x32_bf16 v[60:63], a[136:139], v[112:115], v[60:63]
    v_mfma_f32_16x16x32_bf16 v[48:51], a[100:103], v[104:107], v[48:51]
    v_mfma_f32_16x16x32_bf16 v[48:51], a[104:107], v[124:127], v[48:51]
    v_mfma_f32_16x16x32_bf16 v[48:51], a[108:111], v[108:111], v[48:51]
    v_mfma_f32_16x16x32_bf16 v[48:51], a[112:115], v[128:131], v[48:51]
    v_mfma_f32_16x16x32_bf16 v[48:51], a[116:119], v[112:115], v[48:51]
    v_mfma_f32_16x16x32_bf16 v[52:55], a[80:83], v[104:107], v[52:55]
    v_mfma_f32_16x16x32_bf16 v[52:55], a[84:87], v[124:127], v[52:55]
    v_mfma_f32_16x16x32_bf16 v[52:55], a[88:91], v[108:111], v[52:55]
    v_mfma_f32_16x16x32_bf16 v[52:55], a[92:95], v[128:131], v[52:55]
    v_mfma_f32_16x16x32_bf16 v[52:55], a[96:99], v[112:115], v[52:55]
    v_mfma_f32_16x16x32_bf16 v[84:87], a[60:63], v[104:107], v[84:87]
    v_mfma_f32_16x16x32_bf16 v[84:87], a[64:67], v[124:127], v[84:87]
    v_mfma_f32_16x16x32_bf16 v[84:87], a[68:71], v[108:111], v[84:87]
    v_mfma_f32_16x16x32_bf16 v[84:87], a[72:75], v[128:131], v[84:87]
    v_mfma_f32_16x16x32_bf16 v[84:87], a[76:79], v[112:115], v[84:87]
    v_mfma_f32_16x16x32_bf16 v[88:91], a[40:43], v[104:107], v[88:91]
    v_mfma_f32_16x16x32_bf16 v[88:91], a[44:47], v[124:127], v[88:91]
    v_mfma_f32_16x16x32_bf16 v[88:91], a[48:51], v[108:111], v[88:91]
    v_mfma_f32_16x16x32_bf16 v[88:91], a[52:55], v[128:131], v[88:91]
    v_mfma_f32_16x16x32_bf16 v[88:91], a[56:59], v[112:115], v[88:91]
    v_mfma_f32_16x16x32_bf16 v[68:71], v[212:215], v[104:107], v[68:71]
    v_mfma_f32_16x16x32_bf16 v[68:71], v[216:219], v[124:127], v[68:71]
    v_mfma_f32_16x16x32_bf16 v[68:71], v[220:223], v[108:111], v[68:71]
    v_mfma_f32_16x16x32_bf16 v[68:71], v[224:227], v[128:131], v[68:71]
    v_mfma_f32_16x16x32_bf16 v[68:71], v[228:231], v[112:115], v[68:71]
    v_mfma_f32_16x16x32_bf16 v[56:59], a[240:243], v[104:107], v[56:59]
    v_mfma_f32_16x16x32_bf16 v[56:59], a[244:247], v[124:127], v[56:59]
    v_mfma_f32_16x16x32_bf16 v[56:59], a[248:251], v[108:111], v[56:59]
    v_mfma_f32_16x16x32_bf16 v[56:59], a[252:255], v[128:131], v[56:59]
    v_mfma_f32_16x16x32_bf16 v[56:59], v[188:191], v[112:115], v[56:59]
    v_mfma_f32_16x16x32_bf16 v[92:95], a[200:203], v[104:107], v[92:95]
    v_mfma_f32_16x16x32_bf16 v[92:95], a[204:207], v[124:127], v[92:95]
    v_mfma_f32_16x16x32_bf16 v[92:95], a[208:211], v[108:111], v[92:95]
    v_mfma_f32_16x16x32_bf16 v[92:95], a[212:215], v[128:131], v[92:95]
    s_waitcnt vmcnt(7)
    s_barrier
    ds_read_b128 v[152:155], v26 offset:6192
    v_mfma_f32_16x16x32_bf16 v[92:95], a[216:219], v[112:115], v[92:95]
    s_waitcnt lgkmcnt(1)
    ds_read_b128 v[156:159], v26 offset:6208
    v_mfma_f32_16x16x32_bf16 v[84:87], a[120:123], v[132:135], v[84:87]
    ds_read_b128 v[160:163], v26 offset:6224
    v_mfma_f32_16x16x32_bf16 v[84:87], a[124:127], v[136:139], v[84:87]
    ds_read_b128 v[164:167], v27 offset:6192
    v_mfma_f32_16x16x32_bf16 v[84:87], a[128:131], v[140:143], v[84:87]
    ds_read_b128 v[168:171], v28 offset:6192
    v_mfma_f32_16x16x32_bf16 v[84:87], a[132:135], v[144:147], v[84:87]
    v_mfma_f32_16x16x32_bf16 v[84:87], a[136:139], v[148:151], v[84:87]
    ds_read_b128 v[172:175], v26 offset:22704
    v_mfma_f32_16x16x32_bf16 v[88:91], a[100:103], v[132:135], v[88:91]
    ds_read_b128 v[176:179], v26 offset:22720
    v_mfma_f32_16x16x32_bf16 v[88:91], a[104:107], v[136:139], v[88:91]
    ds_read_b128 v[180:183], v26 offset:22736
    v_mfma_f32_16x16x32_bf16 v[88:91], a[108:111], v[140:143], v[88:91]
    s_mov_b32 s34, 0x23222120
    ds_read_b128 v[184:187], v27 offset:22704
    v_mfma_f32_16x16x32_bf16 v[88:91], a[112:115], v[144:147], v[88:91]
    ds_read_b128 v[96:99], v28 offset:22704
    v_mfma_f32_16x16x32_bf16 v[88:91], a[116:119], v[148:151], v[88:91]
    s_cmp_eq_u32 s27, 1
    s_cselect_b32 s34, 0x2b2a2928, s34
    v_mfma_f32_16x16x32_bf16 v[92:95], v[192:195], v[132:135], v[92:95]
    s_cmp_eq_u32 s27, 2
    s_cselect_b32 s34, 0x33323130, s34
    v_mfma_f32_16x16x32_bf16 v[92:95], v[196:199], v[136:139], v[92:95]
    s_cmp_eq_u32 s27, 3
    s_cselect_b32 s34, 0x2c363534, s34
    v_lshlrev_b32 v4, 1, v1
    v_mfma_f32_16x16x32_bf16 v[92:95], v[200:203], v[140:143], v[92:95]
    v_and_b32 v4, 24, v4
    v_bfe_u32 v4, s34, v4, 8
    v_mfma_f32_16x16x32_bf16 v[92:95], v[204:207], v[144:147], v[92:95]
    v_lshrrev_b32 v5, 3, v4
    v_and_b32 v4, 7, v4
    v_mfma_f32_16x16x32_bf16 v[92:95], v[208:211], v[148:151], v[92:95]
    s_waitcnt lgkmcnt(4)
    v_and_b32 v6, 3, v1
    v_lshl_add_u32 v4, v4, 2, v6
    v_mfma_f32_16x16x32_bf16 v[76:79], a[60:63], v[152:155], v[76:79]
    v_mul_u32_u24 v6, 8256, v5
    v_mad_u32_u24 v6, v4, 48, v6
    v_mfma_f32_16x16x32_bf16 v[76:79], a[64:67], v[156:159], v[76:79]
    v_add_u32 v32, v6, v10
    v_add_u32 v33, v6, v11
    v_mfma_f32_16x16x32_bf16 v[76:79], a[68:71], v[160:163], v[76:79]
    v_add_u32 v34, v6, v12
    v_add_u32 v35, v6, v13
    v_mfma_f32_16x16x32_bf16 v[76:79], a[72:75], v[164:167], v[76:79]
    v_mul_u32_u24 v7, 172032, v5
    v_mul_u32_u24 v4, 192, v4
    v_mfma_f32_16x16x32_bf16 v[76:79], a[76:79], v[168:171], v[76:79]
    v_add_u32 v37, v7, v4
    v_add_u32 v36, v37, v15
    v_mfma_f32_16x16x32_bf16 v[72:75], a[40:43], v[152:155], v[72:75]
    v_mfma_f32_16x16x32_bf16 v[72:75], a[44:47], v[156:159], v[72:75]
    v_mfma_f32_16x16x32_bf16 v[72:75], a[48:51], v[160:163], v[72:75]
    v_mfma_f32_16x16x32_bf16 v[72:75], a[52:55], v[164:167], v[72:75]
    v_mfma_f32_16x16x32_bf16 v[72:75], a[56:59], v[168:171], v[72:75]
    v_mfma_f32_16x16x32_bf16 v[64:67], a[20:23], v[152:155], v[64:67]
    v_mfma_f32_16x16x32_bf16 v[64:67], a[24:27], v[156:159], v[64:67]
    v_mfma_f32_16x16x32_bf16 v[64:67], a[28:31], v[160:163], v[64:67]
    v_mfma_f32_16x16x32_bf16 v[64:67], a[32:35], v[164:167], v[64:67]
    v_mfma_f32_16x16x32_bf16 v[64:67], a[36:39], v[168:171], v[64:67]
    v_mfma_f32_16x16x32_bf16 v[60:63], a[0:3], v[152:155], v[60:63]
    v_mfma_f32_16x16x32_bf16 v[60:63], a[4:7], v[156:159], v[60:63]
    v_mfma_f32_16x16x32_bf16 v[60:63], a[8:11], v[160:163], v[60:63]
    v_mfma_f32_16x16x32_bf16 v[60:63], a[12:15], v[164:167], v[60:63]
    v_mfma_f32_16x16x32_bf16 v[60:63], a[16:19], v[168:171], v[60:63]
    v_mfma_f32_16x16x32_bf16 v[80:83], a[200:203], v[152:155], v[80:83]
    v_mfma_f32_16x16x32_bf16 v[80:83], a[204:207], v[156:159], v[80:83]
    v_mfma_f32_16x16x32_bf16 v[80:83], a[208:211], v[160:163], v[80:83]
    v_mfma_f32_16x16x32_bf16 v[80:83], a[212:215], v[164:167], v[80:83]
    v_mfma_f32_16x16x32_bf16 v[80:83], a[216:219], v[168:171], v[80:83]
    v_mfma_f32_16x16x32_bf16 v[68:71], a[160:163], v[152:155], v[68:71]
    v_mfma_f32_16x16x32_bf16 v[68:71], a[164:167], v[156:159], v[68:71]
    v_mfma_f32_16x16x32_bf16 v[68:71], a[168:171], v[160:163], v[68:71]
    v_mfma_f32_16x16x32_bf16 v[68:71], a[172:175], v[164:167], v[68:71]
    v_mfma_f32_16x16x32_bf16 v[68:71], a[176:179], v[168:171], v[68:71]
    v_mfma_f32_16x16x32_bf16 v[52:55], a[120:123], v[172:175], v[52:55]
    s_waitcnt lgkmcnt(0)
    v_mfma_f32_16x16x32_bf16 v[52:55], a[124:127], v[176:179], v[52:55]
    v_mfma_f32_16x16x32_bf16 v[52:55], a[128:131], v[180:183], v[52:55]
    v_mfma_f32_16x16x32_bf16 v[52:55], a[132:135], v[184:187], v[52:55]
    v_mfma_f32_16x16x32_bf16 v[52:55], a[136:139], v[96:99], v[52:55]
    v_mfma_f32_16x16x32_bf16 v[84:87], a[100:103], v[172:175], v[84:87]
    v_mfma_f32_16x16x32_bf16 v[84:87], a[104:107], v[176:179], v[84:87]
    v_mfma_f32_16x16x32_bf16 v[84:87], a[108:111], v[180:183], v[84:87]
    v_mfma_f32_16x16x32_bf16 v[84:87], a[112:115], v[184:187], v[84:87]
    s_waitcnt vmcnt(6)
    s_barrier
    ds_read_b128 v[116:119], v29 offset:16512
    v_mfma_f32_16x16x32_bf16 v[84:87], a[116:119], v[96:99], v[84:87]
    ds_read_b128 v[100:103], v26 offset:20640
    v_mfma_f32_16x16x32_bf16 v[88:91], a[80:83], v[172:175], v[88:91]
    ds_read_b128 v[120:123], v26 offset:20656
    v_mfma_f32_16x16x32_bf16 v[88:91], a[84:87], v[176:179], v[88:91]
    ds_read_b128 v[104:107], v26 offset:20672
    v_mfma_f32_16x16x32_bf16 v[88:91], a[88:91], v[180:183], v[88:91]
    ds_read_b128 v[124:127], v27 offset:20640
    v_mfma_f32_16x16x32_bf16 v[88:91], a[92:95], v[184:187], v[88:91]
    ds_read_b128 v[108:111], v28 offset:20640
    v_mfma_f32_16x16x32_bf16 v[88:91], a[96:99], v[96:99], v[88:91]
    v_mfma_f32_16x16x32_bf16 v[56:59], v[212:215], v[172:175], v[56:59]
    v_mfma_f32_16x16x32_bf16 v[56:59], v[216:219], v[176:179], v[56:59]
    v_mfma_f32_16x16x32_bf16 v[56:59], v[220:223], v[180:183], v[56:59]
    v_mfma_f32_16x16x32_bf16 v[56:59], v[224:227], v[184:187], v[56:59]
    v_mfma_f32_16x16x32_bf16 v[56:59], v[228:231], v[96:99], v[56:59]
    v_mfma_f32_16x16x32_bf16 v[92:95], a[240:243], v[172:175], v[92:95]
    v_mfma_f32_16x16x32_bf16 v[92:95], a[244:247], v[176:179], v[92:95]
    v_mfma_f32_16x16x32_bf16 v[92:95], a[248:251], v[180:183], v[92:95]
    v_mfma_f32_16x16x32_bf16 v[92:95], a[252:255], v[184:187], v[92:95]
    v_mfma_f32_16x16x32_bf16 v[92:95], v[188:191], v[96:99], v[92:95]
    s_waitcnt lgkmcnt(0)
    v_mfma_f32_16x16x32_bf16 v[48:51], v[236:239], v[116:119], v[48:51]
    v_mfma_f32_16x16x32_bf16 v[52:55], v[244:247], v[116:119], v[52:55]
    v_mfma_f32_16x16x32_bf16 v[56:59], v[252:255], v[116:119], v[56:59]
    v_mfma_f32_16x16x32_bf16 v[48:51], a[120:123], v[100:103], v[48:51]
    v_mfma_f32_16x16x32_bf16 v[48:51], a[124:127], v[120:123], v[48:51]
    v_mfma_f32_16x16x32_bf16 v[48:51], a[128:131], v[104:107], v[48:51]
    v_mfma_f32_16x16x32_bf16 v[48:51], a[132:135], v[124:127], v[48:51]
    v_mfma_f32_16x16x32_bf16 v[48:51], a[136:139], v[108:111], v[48:51]
    v_mfma_f32_16x16x32_bf16 v[52:55], a[100:103], v[100:103], v[52:55]
    v_mfma_f32_16x16x32_bf16 v[52:55], a[104:107], v[120:123], v[52:55]
    v_mfma_f32_16x16x32_bf16 v[52:55], a[108:111], v[104:107], v[52:55]
    v_mfma_f32_16x16x32_bf16 v[52:55], a[112:115], v[124:127], v[52:55]
    v_mfma_f32_16x16x32_bf16 v[52:55], a[116:119], v[108:111], v[52:55]
    s_waitcnt vmcnt(0)
    s_barrier
    ds_read_b128 v[128:131], v29 offset:4128
    v_mfma_f32_16x16x32_bf16 v[84:87], a[80:83], v[100:103], v[84:87]
    ds_read_b128 v[112:115], v26 offset:4128
    v_cvt_pk_bf16_f32 v48, v48, v49
    v_mfma_f32_16x16x32_bf16 v[84:87], a[84:87], v[120:123], v[84:87]
    ds_read_b128 v[132:135], v26 offset:4144
    v_cvt_pk_bf16_f32 v49, v50, v51
    v_mfma_f32_16x16x32_bf16 v[84:87], a[88:91], v[104:107], v[84:87]
    ds_read_b128 v[136:139], v26 offset:4160
    v_cvt_pk_bf16_f32 v52, v52, v53
    v_mfma_f32_16x16x32_bf16 v[84:87], a[92:95], v[124:127], v[84:87]
    ds_read_b128 v[140:143], v27 offset:4128
    v_cvt_pk_bf16_f32 v53, v54, v55
    v_mfma_f32_16x16x32_bf16 v[84:87], a[96:99], v[108:111], v[84:87]
    ds_read_b128 v[144:147], v28 offset:4128
    v_mfma_f32_16x16x32_bf16 v[88:91], a[60:63], v[100:103], v[88:91]
    v_mfma_f32_16x16x32_bf16 v[88:91], a[64:67], v[120:123], v[88:91]
    v_mfma_f32_16x16x32_bf16 v[88:91], a[68:71], v[104:107], v[88:91]
    ds_read_b128 v[148:151], v26 offset:2064
    v_mfma_f32_16x16x32_bf16 v[88:91], a[72:75], v[124:127], v[88:91]
    ds_read_b128 v[152:155], v26 offset:2080
    v_mfma_f32_16x16x32_bf16 v[88:91], a[76:79], v[108:111], v[88:91]
    ds_read_b128 v[156:159], v26 offset:2096
    v_mfma_f32_16x16x32_bf16 v[56:59], v[192:195], v[100:103], v[56:59]
    ds_read_b128 v[160:163], v27 offset:2064
    v_mfma_f32_16x16x32_bf16 v[56:59], v[196:199], v[120:123], v[56:59]
    ds_read_b128 v[164:167], v28 offset:2064
    v_mfma_f32_16x16x32_bf16 v[56:59], v[200:203], v[104:107], v[56:59]
    v_mfma_f32_16x16x32_bf16 v[56:59], v[204:207], v[124:127], v[56:59]
    v_mfma_f32_16x16x32_bf16 v[56:59], v[208:211], v[108:111], v[56:59]
    v_mfma_f32_16x16x32_bf16 v[92:95], a[220:223], v[100:103], v[92:95]
    v_mfma_f32_16x16x32_bf16 v[92:95], a[224:227], v[120:123], v[92:95]
    v_mfma_f32_16x16x32_bf16 v[92:95], a[228:231], v[104:107], v[92:95]
    v_mfma_f32_16x16x32_bf16 v[92:95], a[232:235], v[124:127], v[92:95]
    v_mfma_f32_16x16x32_bf16 v[92:95], a[236:239], v[108:111], v[92:95]
    s_waitcnt lgkmcnt(2)
    v_mfma_f32_16x16x32_bf16 v[64:67], v[232:235], v[128:131], v[64:67]
    v_mfma_f32_16x16x32_bf16 v[60:63], v[240:243], v[128:131], v[60:63]
    v_mfma_f32_16x16x32_bf16 v[68:71], v[248:251], v[128:131], v[68:71]
    ds_read_b128 v[168:171], v29 offset:0
    v_cvt_pk_bf16_f32 v56, v56, v57
    v_mfma_f32_16x16x32_bf16 v[76:79], a[40:43], v[112:115], v[76:79]
    v_cvt_pk_bf16_f32 v57, v58, v59
    v_mfma_f32_16x16x32_bf16 v[76:79], a[44:47], v[132:135], v[76:79]
    v_mfma_f32_16x16x32_bf16 v[76:79], a[48:51], v[136:139], v[76:79]
    ds_read_b128 v[172:175], v26 offset:0
    v_permlane32_swap_b32 v56, v57
    v_mfma_f32_16x16x32_bf16 v[76:79], a[52:55], v[140:143], v[76:79]
    ds_read_b128 v[176:179], v26 offset:16
    v_cndmask_b32 v50, v49, v56, s[8:9]
    v_mfma_f32_16x16x32_bf16 v[76:79], a[56:59], v[144:147], v[76:79]
    ds_read_b128 v[180:183], v26 offset:32
    v_cndmask_b32 v49, v48, v49, s[8:9]
    v_mfma_f32_16x16x32_bf16 v[72:75], a[20:23], v[112:115], v[72:75]
    ds_read_b128 v[184:187], v27 offset:0
    v_cndmask_b32 v48, v56, v48, s[8:9]
    v_mfma_f32_16x16x32_bf16 v[72:75], a[24:27], v[132:135], v[72:75]
    buffer_store_dwordx3 v[48:50], v30, s[20:23], s48 offen
    v_mfma_f32_16x16x32_bf16 v[72:75], a[28:31], v[136:139], v[72:75]
    ds_read_b128 v[96:99], v28 offset:0
    v_cndmask_b32 v54, v53, v57, s[8:9]
    v_mfma_f32_16x16x32_bf16 v[72:75], a[32:35], v[140:143], v[72:75]
    v_cndmask_b32 v53, v52, v53, s[8:9]
    v_cndmask_b32 v52, v57, v52, s[8:9]
    v_mfma_f32_16x16x32_bf16 v[72:75], a[36:39], v[144:147], v[72:75]
    v_mfma_f32_16x16x32_bf16 v[64:67], a[0:3], v[112:115], v[64:67]
    v_mfma_f32_16x16x32_bf16 v[64:67], a[4:7], v[132:135], v[64:67]
    v_mfma_f32_16x16x32_bf16 v[64:67], a[8:11], v[136:139], v[64:67]
    ds_read_b128 v[116:119], v29 offset:20640
    v_mfma_f32_16x16x32_bf16 v[64:67], a[12:15], v[140:143], v[64:67]
    buffer_store_dwordx3 v[52:54], v30, s[20:23], s49 offen
    v_mfma_f32_16x16x32_bf16 v[64:67], a[16:19], v[144:147], v[64:67]
    v_cvt_pk_bf16_f32 v60, v60, v61
    v_cvt_pk_bf16_f32 v61, v62, v63
    v_mfma_f32_16x16x32_bf16 v[80:83], a[180:183], v[112:115], v[80:83]
    ds_read_b128 v[100:103], v26 offset:26832
    v_mfma_f32_16x16x32_bf16 v[80:83], a[184:187], v[132:135], v[80:83]
    ds_read_b128 v[120:123], v26 offset:26848
    v_mfma_f32_16x16x32_bf16 v[80:83], a[188:191], v[136:139], v[80:83]
    ds_read_b128 v[104:107], v26 offset:26864
    v_mfma_f32_16x16x32_bf16 v[80:83], a[192:195], v[140:143], v[80:83]
    ds_read_b128 v[124:127], v27 offset:26832
    v_cvt_pk_bf16_f32 v64, v64, v65
    v_mfma_f32_16x16x32_bf16 v[80:83], a[196:199], v[144:147], v[80:83]
    ds_read_b128 v[108:111], v28 offset:26832
    v_cvt_pk_bf16_f32 v65, v66, v67
    v_mfma_f32_16x16x32_bf16 v[68:71], a[140:143], v[112:115], v[68:71]
    v_mfma_f32_16x16x32_bf16 v[68:71], a[144:147], v[132:135], v[68:71]
    v_mfma_f32_16x16x32_bf16 v[68:71], a[148:151], v[136:139], v[68:71]
    v_mfma_f32_16x16x32_bf16 v[68:71], a[152:155], v[140:143], v[68:71]
    v_mfma_f32_16x16x32_bf16 v[68:71], a[156:159], v[144:147], v[68:71]
    v_mfma_f32_16x16x32_bf16 v[76:79], a[20:23], v[148:151], v[76:79]
    ds_read_b128 v[128:131], v32 offset:0
    v_mfma_f32_16x16x32_bf16 v[76:79], a[24:27], v[152:155], v[76:79]
    ds_read_b128 v[112:115], v32 offset:16
    v_mfma_f32_16x16x32_bf16 v[76:79], a[28:31], v[156:159], v[76:79]
    s_waitcnt lgkmcnt(4)
    ds_read_b128 v[132:135], v32 offset:32
    v_mfma_f32_16x16x32_bf16 v[76:79], a[32:35], v[160:163], v[76:79]
    ds_read_b128 v[136:139], v33 offset:0
    v_mfma_f32_16x16x32_bf16 v[76:79], a[36:39], v[164:167], v[76:79]
    ds_read_b128 v[140:143], v34 offset:0
    v_cvt_pk_bf16_f32 v68, v68, v69
    v_mfma_f32_16x16x32_bf16 v[72:75], a[0:3], v[148:151], v[72:75]
    v_cvt_pk_bf16_f32 v69, v70, v71
    v_mfma_f32_16x16x32_bf16 v[72:75], a[4:7], v[152:155], v[72:75]
    v_mfma_f32_16x16x32_bf16 v[72:75], a[8:11], v[156:159], v[72:75]
    v_mfma_f32_16x16x32_bf16 v[72:75], a[12:15], v[160:163], v[72:75]
    v_permlane32_swap_b32 v68, v69
    v_cndmask_b32 v66, v65, v68, s[8:9]
    v_mfma_f32_16x16x32_bf16 v[72:75], a[16:19], v[164:167], v[72:75]
    v_cndmask_b32 v65, v64, v65, s[8:9]
    v_cndmask_b32 v64, v68, v64, s[8:9]
    v_mfma_f32_16x16x32_bf16 v[80:83], a[160:163], v[148:151], v[80:83]
    buffer_store_dwordx3 v[64:66], v30, s[20:23], s46 offen
    v_mfma_f32_16x16x32_bf16 v[80:83], a[164:167], v[152:155], v[80:83]
    ds_read_b128 v[144:147], v32 offset:2064
    v_cndmask_b32 v62, v61, v69, s[8:9]
    v_mfma_f32_16x16x32_bf16 v[80:83], a[168:171], v[156:159], v[80:83]
    ds_read_b128 v[148:151], v32 offset:2080
    v_cndmask_b32 v61, v60, v61, s[8:9]
    v_mfma_f32_16x16x32_bf16 v[80:83], a[172:175], v[160:163], v[80:83]
    ds_read_b128 v[152:155], v32 offset:2096
    v_cndmask_b32 v60, v69, v60, s[8:9]
    v_mfma_f32_16x16x32_bf16 v[80:83], a[176:179], v[164:167], v[80:83]
    ds_read_b128 v[156:159], v33 offset:2064
    v_mfma_f32_16x16x32_bf16 v[76:79], v[232:235], v[168:171], v[76:79]
    ds_read_b128 v[160:163], v34 offset:2064
    v_mfma_f32_16x16x32_bf16 v[72:75], v[240:243], v[168:171], v[72:75]
    v_mfma_f32_16x16x32_bf16 v[80:83], v[248:251], v[168:171], v[80:83]
    buffer_store_dwordx3 v[60:62], v30, s[20:23], s47 offen
    v_mfma_f32_16x16x32_bf16 v[76:79], a[0:3], v[172:175], v[76:79]
    v_mfma_f32_16x16x32_bf16 v[76:79], a[4:7], v[176:179], v[76:79]
    v_mfma_f32_16x16x32_bf16 v[76:79], a[8:11], v[180:183], v[76:79]
    v_mfma_f32_16x16x32_bf16 v[76:79], a[12:15], v[184:187], v[76:79]
    v_mfma_f32_16x16x32_bf16 v[76:79], a[16:19], v[96:99], v[76:79]
    v_mfma_f32_16x16x32_bf16 v[80:83], a[140:143], v[172:175], v[80:83]
    v_mfma_f32_16x16x32_bf16 v[80:83], a[144:147], v[176:179], v[80:83]
    v_mfma_f32_16x16x32_bf16 v[80:83], a[148:151], v[180:183], v[80:83]
    ds_read_b128 v[164:167], v32 offset:4128
    v_cvt_pk_bf16_f32 v72, v72, v73
    v_mfma_f32_16x16x32_bf16 v[80:83], a[152:155], v[184:187], v[80:83]
    ds_read_b128 v[168:171], v32 offset:4144
    v_cvt_pk_bf16_f32 v73, v74, v75
    v_mfma_f32_16x16x32_bf16 v[80:83], a[156:159], v[96:99], v[80:83]
    ds_read_b128 v[172:175], v32 offset:4160
    v_cvt_pk_bf16_f32 v76, v76, v77
    v_mfma_f32_16x16x32_bf16 v[84:87], v[236:239], v[116:119], v[84:87]
    ds_read_b128 v[176:179], v33 offset:4128
    v_cvt_pk_bf16_f32 v77, v78, v79
    v_mfma_f32_16x16x32_bf16 v[88:91], v[244:247], v[116:119], v[88:91]
    ds_read_b128 v[180:183], v34 offset:4128
    v_mfma_f32_16x16x32_bf16 v[92:95], v[252:255], v[116:119], v[92:95]
    v_mfma_f32_16x16x32_bf16 v[88:91], a[120:123], v[100:103], v[88:91]
    v_mfma_f32_16x16x32_bf16 v[88:91], a[124:127], v[120:123], v[88:91]
    v_cvt_pk_bf16_f32 v80, v80, v81
    v_cvt_pk_bf16_f32 v81, v82, v83
    v_mfma_f32_16x16x32_bf16 v[88:91], a[128:131], v[104:107], v[88:91]
    s_waitcnt lgkmcnt(5)
    v_mfma_f32_16x16x32_bf16 v[88:91], a[132:135], v[124:127], v[88:91]
    v_permlane32_swap_b32 v80, v81
    v_cndmask_b32 v78, v77, v80, s[8:9]
    v_mfma_f32_16x16x32_bf16 v[88:91], a[136:139], v[108:111], v[88:91]
    v_cndmask_b32 v77, v76, v77, s[8:9]
    v_cndmask_b32 v76, v80, v76, s[8:9]
    v_mfma_f32_16x16x32_bf16 v[92:95], v[212:215], v[100:103], v[92:95]
    buffer_store_dwordx3 v[76:78], v30, s[20:23], s44 offen
    v_mfma_f32_16x16x32_bf16 v[92:95], v[216:219], v[120:123], v[92:95]
    v_cndmask_b32 v74, v73, v81, s[8:9]
    v_cndmask_b32 v73, v72, v73, s[8:9]
    v_mfma_f32_16x16x32_bf16 v[92:95], v[220:223], v[104:107], v[92:95]
    v_cndmask_b32 v72, v81, v72, s[8:9]
    v_mfma_f32_16x16x32_bf16 v[92:95], v[224:227], v[124:127], v[92:95]
    v_mfma_f32_16x16x32_bf16 v[92:95], v[228:231], v[108:111], v[92:95]
    v_mfma_f32_16x16x32_bf16 v[48:51], a[0:3], v[128:131], 0
    v_mfma_f32_16x16x32_bf16 v[48:51], a[4:7], v[112:115], v[48:51]
    v_mfma_f32_16x16x32_bf16 v[48:51], a[8:11], v[132:135], v[48:51]
    buffer_store_dwordx3 v[72:74], v30, s[20:23], s45 offen
    v_mfma_f32_16x16x32_bf16 v[48:51], a[12:15], v[136:139], v[48:51]
    v_cvt_pk_bf16_f32 v84, v84, v85
    v_cvt_pk_bf16_f32 v85, v86, v87
    v_mfma_f32_16x16x32_bf16 v[48:51], a[16:19], v[140:143], v[48:51]
    v_cvt_pk_bf16_f32 v88, v88, v89
    v_cvt_pk_bf16_f32 v89, v90, v91
    v_mfma_f32_16x16x32_bf16 v[52:55], a[140:143], v[128:131], 0
    v_cvt_pk_bf16_f32 v92, v92, v93
    v_cvt_pk_bf16_f32 v93, v94, v95
    v_mfma_f32_16x16x32_bf16 v[52:55], a[144:147], v[112:115], v[52:55]
    v_mfma_f32_16x16x32_bf16 v[52:55], a[148:151], v[132:135], v[52:55]
    v_mfma_f32_16x16x32_bf16 v[52:55], a[152:155], v[136:139], v[52:55]
    v_permlane32_swap_b32 v92, v93
    v_cndmask_b32 v86, v85, v92, s[8:9]
    v_mfma_f32_16x16x32_bf16 v[52:55], a[156:159], v[140:143], v[52:55]
    ds_read_b128 v[184:187], v32 offset:6192
    v_cndmask_b32 v85, v84, v85, s[8:9]
    v_mfma_f32_16x16x32_bf16 v[48:51], a[20:23], v[144:147], v[48:51]
    ds_read_b128 v[96:99], v32 offset:6208
    v_cndmask_b32 v84, v92, v84, s[8:9]
    v_mfma_f32_16x16x32_bf16 v[48:51], a[24:27], v[148:151], v[48:51]
    buffer_store_dwordx3 v[84:86], v30, s[20:23], s50 offen
    v_mfma_f32_16x16x32_bf16 v[48:51], a[28:31], v[152:155], v[48:51]
    ds_read_b128 v[116:119], v32 offset:6224
    v_cndmask_b32 v90, v89, v93, s[8:9]
    v_mfma_f32_16x16x32_bf16 v[48:51], a[32:35], v[156:159], v[48:51]
    ds_read_b128 v[100:103], v33 offset:6192
    v_cndmask_b32 v89, v88, v89, s[8:9]
    v_mfma_f32_16x16x32_bf16 v[48:51], a[36:39], v[160:163], v[48:51]
    ds_read_b128 v[120:123], v34 offset:6192
    v_cndmask_b32 v88, v93, v88, s[8:9]
    v_mfma_f32_16x16x32_bf16 v[56:59], a[0:3], v[144:147], 0
    v_mfma_f32_16x16x32_bf16 v[56:59], a[4:7], v[148:151], v[56:59]
    v_mfma_f32_16x16x32_bf16 v[56:59], a[8:11], v[152:155], v[56:59]
    v_mfma_f32_16x16x32_bf16 v[56:59], a[12:15], v[156:159], v[56:59]
    buffer_store_dwordx3 v[88:90], v30, s[20:23], s51 offen
    v_mfma_f32_16x16x32_bf16 v[56:59], a[16:19], v[160:163], v[56:59]
    s_lshr_b32 s32, s27, 1
    s_mul_i32 s33, s32, 8256
    s_add_u32 s33, s33, 33792
    v_mfma_f32_16x16x32_bf16 v[52:55], a[160:163], v[144:147], v[52:55]
    v_bfe_u32 v5, v1, 2, 2
    v_and_b32 v4, 3, v1
    v_mfma_f32_16x16x32_bf16 v[52:55], a[164:167], v[148:151], v[52:55]
    v_mul_u32_u24 v6, 2064, v5
    v_mad_u32_u24 v6, v4, 48, v6
    v_mfma_f32_16x16x32_bf16 v[52:55], a[168:171], v[152:155], v[52:55]
    v_add3_u32 v26, v6, v10, s33
    v_add3_u32 v27, v6, v11, s33
    v_mfma_f32_16x16x32_bf16 v[52:55], a[172:175], v[156:159], v[52:55]
    v_add3_u32 v28, v6, v12, s33
    v_add3_u32 v29, v6, v13, s33
    v_mfma_f32_16x16x32_bf16 v[52:55], a[176:179], v[160:163], v[52:55]
    s_waitcnt lgkmcnt(0)
    s_mul_i32 s34, s32, 33280
    v_mfma_f32_16x16x32_bf16 v[48:51], a[40:43], v[164:167], v[48:51]
    s_bitcmp1_b32 s27, 0
    s_cselect_b64 vcc, -1, 0
    v_add_u32 v7, 8320, v23
    v_mfma_f32_16x16x32_bf16 v[48:51], a[44:47], v[168:171], v[48:51]
    v_cndmask_b32 v76, v21, v22, vcc
    v_cndmask_b32 v86, v7, v24, vcc
    v_mfma_f32_16x16x32_bf16 v[48:51], a[48:51], v[172:175], v[48:51]
    v_add_u32 v76, s34, v76
    v_add_u32 v86, s34, v86
    v_mfma_f32_16x16x32_bf16 v[48:51], a[52:55], v[176:179], v[48:51]
    v_mul_u32_u24 v7, 43008, v5
    v_mul_u32_u24 v4, 192, v4
    v_mfma_f32_16x16x32_bf16 v[48:51], a[56:59], v[180:183], v[48:51]
    v_add3_u32 v7, v7, v4, v14
    s_and_b32 s36, s27, 1
    v_mfma_f32_16x16x32_bf16 v[56:59], a[20:23], v[164:167], v[56:59]
    s_lshl_b32 s36, s36, 3
    s_add_u32 s36, s36, 691200
    v_add_u32 v7, s36, v7
    v_mfma_f32_16x16x32_bf16 v[56:59], a[24:27], v[168:171], v[56:59]
    s_movk_i32 s36, 96
    v_cmp_gt_u32 vcc, s36, v0
    v_bfrev_b32 v8, 1
    v_mfma_f32_16x16x32_bf16 v[56:59], a[28:31], v[172:175], v[56:59]
    v_lshlrev_b32 v31, 4, v0
    v_add_u32 v31, 145056, v31
    v_mfma_f32_16x16x32_bf16 v[56:59], a[32:35], v[176:179], v[56:59]
    v_cndmask_b32 v30, v8, v7, vcc
    v_xor_b32 v87, 128, v0
    v_mfma_f32_16x16x32_bf16 v[56:59], a[36:39], v[180:183], v[56:59]
    v_lshlrev_b32 v87, 4, v87
    v_add_u32 v87, 145056, v87
    v_mfma_f32_16x16x32_bf16 v[60:63], a[0:3], v[164:167], 0
    ds_read_b128 v[104:107], v26 offset:0
    v_mfma_f32_16x16x32_bf16 v[60:63], a[4:7], v[168:171], v[60:63]
    ds_read_b64_tr_b16 v[124:125], v76 offset:0
    v_mfma_f32_16x16x32_bf16 v[60:63], a[8:11], v[172:175], v[60:63]
    ds_read_b64_tr_b16 v[126:127], v76 offset:768
    v_mfma_f32_16x16x32_bf16 v[60:63], a[12:15], v[176:179], v[60:63]
    ds_read_b128 v[108:111], v26 offset:16
    v_mfma_f32_16x16x32_bf16 v[60:63], a[16:19], v[180:183], v[60:63]
    ds_read_b64_tr_b16 v[128:129], v76 offset:1536
    v_mfma_f32_16x16x32_bf16 v[52:55], a[180:183], v[164:167], v[52:55]
    ds_read_b64_tr_b16 v[130:131], v76 offset:2304
    v_mfma_f32_16x16x32_bf16 v[52:55], a[184:187], v[168:171], v[52:55]
    ds_read_b128 v[112:115], v26 offset:32
    v_mfma_f32_16x16x32_bf16 v[52:55], a[188:191], v[172:175], v[52:55]
    ds_read_b64_tr_b16 v[132:133], v76 offset:3072
    v_mfma_f32_16x16x32_bf16 v[52:55], a[192:195], v[176:179], v[52:55]
L_stub1:
    s_cbranch_execz L_stub5
    ds_read_b64_tr_b16 v[134:135], v76 offset:3840
    v_mfma_f32_16x16x32_bf16 v[52:55], a[196:199], v[180:183], v[52:55]
    ds_read_b128 v[136:139], v27 offset:0
    v_mfma_f32_16x16x32_bf16 v[64:67], a[140:143], v[164:167], 0
    ds_read_b64_tr_b16 v[140:141], v76 offset:4608
    v_mfma_f32_16x16x32_bf16 v[64:67], a[144:147], v[168:171], v[64:67]
    ds_read_b64_tr_b16 v[142:143], v76 offset:5376
    v_mfma_f32_16x16x32_bf16 v[64:67], a[148:151], v[172:175], v[64:67]
    ds_read_b128 v[144:147], v28 offset:0
    v_mfma_f32_16x16x32_bf16 v[64:67], a[152:155], v[176:179], v[64:67]
    ds_read_b64_tr_b16 v[148:149], v76 offset:6144
    v_mfma_f32_16x16x32_bf16 v[64:67], a[156:159], v[180:183], v[64:67]
    ds_read_b64_tr_b16 v[150:151], v76 offset:6912
    v_mfma_f32_16x16x32_bf16 v[48:51], a[60:63], v[184:187], v[48:51]
    ds_read_b128 v[152:155], v35 offset:0
    v_mfma_f32_16x16x32_bf16 v[48:51], a[64:67], v[96:99], v[48:51]
    ds_read_b128 v[156:159], v32 offset:8256
    v_mfma_f32_16x16x32_bf16 v[48:51], a[68:71], v[116:119], v[48:51]
    ds_read_b128 v[160:163], v32 offset:8272
    v_mfma_f32_16x16x32_bf16 v[48:51], a[72:75], v[100:103], v[48:51]
    ds_read_b128 v[164:167], v32 offset:8288
    v_mfma_f32_16x16x32_bf16 v[48:51], a[76:79], v[120:123], v[48:51]
    ds_read_b128 v[168:171], v33 offset:8256
    v_mfma_f32_16x16x32_bf16 v[56:59], a[40:43], v[184:187], v[56:59]
    ds_read_b128 v[172:175], v34 offset:8256
    v_mfma_f32_16x16x32_bf16 v[56:59], a[44:47], v[96:99], v[56:59]
    ds_read_b128 v[176:179], v26 offset:2064
    v_mfma_f32_16x16x32_bf16 v[56:59], a[48:51], v[116:119], v[56:59]
    ds_read_b64_tr_b16 v[180:181], v76 offset:8320
    v_mfma_f32_16x16x32_bf16 v[56:59], a[52:55], v[100:103], v[56:59]
    ds_read_b64_tr_b16 v[182:183], v76 offset:9088
    v_mfma_f32_16x16x32_bf16 v[56:59], a[56:59], v[120:123], v[56:59]
    s_waitcnt lgkmcnt(9)
    v_mfma_f32_16x16x32_bf16 v[72:75], v[124:127], v[104:107], 0
    ds_read_b128 v[104:107], v26 offset:2080
    v_mfma_f32_16x16x32_bf16 v[60:63], a[20:23], v[184:187], v[60:63]
    ds_read_b64_tr_b16 v[124:125], v76 offset:9856
    v_mfma_f32_16x16x32_bf16 v[60:63], a[24:27], v[96:99], v[60:63]
    ds_read_b64_tr_b16 v[126:127], v76 offset:10624
    v_mfma_f32_16x16x32_bf16 v[60:63], a[28:31], v[116:119], v[60:63]
    v_mfma_f32_16x16x32_bf16 v[60:63], a[32:35], v[100:103], v[60:63]
    v_mfma_f32_16x16x32_bf16 v[60:63], a[36:39], v[120:123], v[60:63]
    v_mfma_f32_16x16x32_bf16 v[72:75], v[128:131], v[108:111], v[72:75]
    ds_read_b128 v[108:111], v26 offset:2096
    v_mfma_f32_16x16x32_bf16 v[68:71], a[0:3], v[184:187], 0
    ds_read_b64_tr_b16 v[128:129], v76 offset:11392
    v_mfma_f32_16x16x32_bf16 v[68:71], a[4:7], v[96:99], v[68:71]
    ds_read_b64_tr_b16 v[130:131], v76 offset:12160
    v_mfma_f32_16x16x32_bf16 v[68:71], a[8:11], v[116:119], v[68:71]
    v_mfma_f32_16x16x32_bf16 v[68:71], a[12:15], v[100:103], v[68:71]
    v_mfma_f32_16x16x32_bf16 v[68:71], a[16:19], v[120:123], v[68:71]
    v_mfma_f32_16x16x32_bf16 v[72:75], v[132:135], v[112:115], v[72:75]
    ds_read_b128 v[112:115], v27 offset:2064
    v_mfma_f32_16x16x32_bf16 v[52:55], a[200:203], v[184:187], v[52:55]
    ds_read_b64_tr_b16 v[132:133], v76 offset:12928
    v_mfma_f32_16x16x32_bf16 v[52:55], a[204:207], v[96:99], v[52:55]
    ds_read_b64_tr_b16 v[134:135], v76 offset:13696
    v_mfma_f32_16x16x32_bf16 v[52:55], a[208:211], v[116:119], v[52:55]
    v_mfma_f32_16x16x32_bf16 v[52:55], a[212:215], v[100:103], v[52:55]
    v_mfma_f32_16x16x32_bf16 v[52:55], a[216:219], v[120:123], v[52:55]
    v_mfma_f32_16x16x32_bf16 v[72:75], v[140:143], v[136:139], v[72:75]
    ds_read_b128 v[136:139], v28 offset:2064
    v_mfma_f32_16x16x32_bf16 v[64:67], a[160:163], v[184:187], v[64:67]
    ds_read_b64_tr_b16 v[140:141], v76 offset:14464
    v_mfma_f32_16x16x32_bf16 v[64:67], a[164:167], v[96:99], v[64:67]
    ds_read_b64_tr_b16 v[142:143], v76 offset:15232
    v_mfma_f32_16x16x32_bf16 v[64:67], a[168:171], v[116:119], v[64:67]
    v_mfma_f32_16x16x32_bf16 v[64:67], a[172:175], v[100:103], v[64:67]
    ds_read_b128 v[184:187], v26 offset:4128
    v_mfma_f32_16x16x32_bf16 v[64:67], a[176:179], v[120:123], v[64:67]
    ds_read_b64_tr_b16 v[96:97], v76 offset:16640
    v_mfma_f32_16x16x32_bf16 v[72:75], v[148:151], v[144:147], v[72:75]
    s_waitcnt lgkmcnt(5)
    ds_read_b64_tr_b16 v[98:99], v76 offset:17408
    v_mfma_f32_16x16x32_bf16 v[48:51], v[232:235], v[152:155], v[48:51]
    ds_read_b128 v[116:119], v32 offset:10320
    v_mfma_f32_16x16x32_bf16 v[56:59], v[240:243], v[152:155], v[56:59]
    ds_read_b128 v[100:103], v32 offset:10336
    v_mfma_f32_16x16x32_bf16 v[52:55], v[248:251], v[152:155], v[52:55]
    ds_read_b128 v[120:123], v32 offset:10352
    v_mfma_f32_16x16x32_bf16 v[48:51], a[80:83], v[156:159], v[48:51]
    ds_read_b128 v[144:147], v33 offset:10320
    v_mfma_f32_16x16x32_bf16 v[48:51], a[84:87], v[160:163], v[48:51]
    ds_read_b128 v[148:151], v34 offset:10320
    v_mfma_f32_16x16x32_bf16 v[48:51], a[88:91], v[164:167], v[48:51]
    ds_read_b128 v[152:155], v26 offset:4144
    v_mfma_f32_16x16x32_bf16 v[48:51], a[92:95], v[168:171], v[48:51]
    v_mfma_f32_16x16x32_bf16 v[48:51], a[96:99], v[172:175], v[48:51]
    v_mfma_f32_16x16x32_bf16 v[72:75], v[180:183], v[176:179], v[72:75]
    ds_read_b64_tr_b16 v[176:177], v76 offset:18176
    v_mfma_f32_16x16x32_bf16 v[56:59], a[60:63], v[156:159], v[56:59]
    ds_read_b64_tr_b16 v[178:179], v76 offset:18944
    v_mfma_f32_16x16x32_bf16 v[56:59], a[64:67], v[160:163], v[56:59]
    ds_read_b128 v[180:183], v26 offset:4160
    v_mfma_f32_16x16x32_bf16 v[56:59], a[68:71], v[164:167], v[56:59]
    v_mfma_f32_16x16x32_bf16 v[56:59], a[72:75], v[168:171], v[56:59]
L_stub2:
    s_cbranch_execz L_back
    v_mfma_f32_16x16x32_bf16 v[56:59], a[76:79], v[172:175], v[56:59]
    v_mfma_f32_16x16x32_bf16 v[72:75], v[124:127], v[104:107], v[72:75]
    ds_read_b64_tr_b16 v[104:105], v76 offset:19712
    v_mfma_f32_16x16x32_bf16 v[60:63], a[40:43], v[156:159], v[60:63]
    ds_read_b64_tr_b16 v[106:107], v76 offset:20480
    v_mfma_f32_16x16x32_bf16 v[60:63], a[44:47], v[160:163], v[60:63]
    ds_read_b128 v[124:127], v27 offset:4128
    v_mfma_f32_16x16x32_bf16 v[60:63], a[48:51], v[164:167], v[60:63]
    v_mfma_f32_16x16x32_bf16 v[60:63], a[52:55], v[168:171], v[60:63]
    v_mfma_f32_16x16x32_bf16 v[60:63], a[56:59], v[172:175], v[60:63]
    v_mfma_f32_16x16x32_bf16 v[72:75], v[128:131], v[108:111], v[72:75]
    s_cmp_eq_u32 s11, 0
    s_cbranch_scc0 L_wb0
    buffer_wbl2 sc1
L_wb0:
    ds_read_b64_tr_b16 v[108:109], v76 offset:21248
    v_mfma_f32_16x16x32_bf16 v[68:71], a[20:23], v[156:159], v[68:71]
    ds_read_b64_tr_b16 v[110:111], v76 offset:22016
    v_mfma_f32_16x16x32_bf16 v[68:71], a[24:27], v[160:163], v[68:71]
    ds_read_b128 v[128:131], v35 offset:4128
    v_mfma_f32_16x16x32_bf16 v[68:71], a[28:31], v[164:167], v[68:71]
    v_mfma_f32_16x16x32_bf16 v[68:71], a[32:35], v[168:171], v[68:71]
    v_mfma_f32_16x16x32_bf16 v[68:71], a[36:39], v[172:175], v[68:71]
    v_mfma_f32_16x16x32_bf16 v[72:75], v[132:135], v[112:115], v[72:75]
    ds_read_b128 v[112:115], v32 offset:12384
    v_mfma_f32_16x16x32_bf16 v[52:55], a[220:223], v[156:159], v[52:55]
    ds_read_b128 v[132:135], v32 offset:12400
    v_mfma_f32_16x16x32_bf16 v[52:55], a[224:227], v[160:163], v[52:55]
    v_mfma_f32_16x16x32_bf16 v[52:55], a[228:231], v[164:167], v[52:55]
    v_mfma_f32_16x16x32_bf16 v[52:55], a[232:235], v[168:171], v[52:55]
    v_mfma_f32_16x16x32_bf16 v[52:55], a[236:239], v[172:175], v[52:55]
    s_waitcnt lgkmcnt(3)
    v_mfma_f32_16x16x32_bf16 v[72:75], v[140:143], v[136:139], v[72:75]
    ds_read_b128 v[136:139], v32 offset:12416
    v_mfma_f32_16x16x32_bf16 v[64:67], a[180:183], v[156:159], v[64:67]
    ds_read_b128 v[140:143], v33 offset:12384
    v_mfma_f32_16x16x32_bf16 v[64:67], a[184:187], v[160:163], v[64:67]
    ds_read_b128 v[156:159], v34 offset:12384
    v_mfma_f32_16x16x32_bf16 v[64:67], a[188:191], v[164:167], v[64:67]
    ds_read_b128 v[160:163], v28 offset:4128
    v_mfma_f32_16x16x32_bf16 v[64:67], a[192:195], v[168:171], v[64:67]
    ds_read_b64_tr_b16 v[164:165], v76 offset:22784
    v_mfma_f32_16x16x32_bf16 v[64:67], a[196:199], v[172:175], v[64:67]
    ds_read_b64_tr_b16 v[166:167], v76 offset:23552
    v_mfma_f32_16x16x32_bf16 v[72:75], v[96:99], v[184:187], v[72:75]
    ds_read_b128 v[168:171], v26 offset:6192
    v_mfma_f32_16x16x32_bf16 v[48:51], a[100:103], v[116:119], v[48:51]
    ds_read_b64_tr_b16 v[172:173], v76 offset:24960
    v_mfma_f32_16x16x32_bf16 v[48:51], a[104:107], v[100:103], v[48:51]
    ds_read_b64_tr_b16 v[174:175], v76 offset:25728
    v_mfma_f32_16x16x32_bf16 v[48:51], a[108:111], v[120:123], v[48:51]
    ds_read_b128 v[184:187], v26 offset:6208
    v_mfma_f32_16x16x32_bf16 v[48:51], a[112:115], v[144:147], v[48:51]
    ds_read_b64_tr_b16 v[96:97], v76 offset:26496
    v_mfma_f32_16x16x32_bf16 v[48:51], a[116:119], v[148:151], v[48:51]
    ds_read_b64_tr_b16 v[98:99], v76 offset:27264
    v_mfma_f32_16x16x32_bf16 v[72:75], v[176:179], v[152:155], v[72:75]
    ds_read_b128 v[152:155], v35 offset:8256
    v_mfma_f32_16x16x32_bf16 v[56:59], a[80:83], v[116:119], v[56:59]
    ds_read_b128 v[176:179], v32 offset:14448
    v_mfma_f32_16x16x32_bf16 v[56:59], a[84:87], v[100:103], v[56:59]
    v_mfma_f32_16x16x32_bf16 v[56:59], a[88:91], v[120:123], v[56:59]
    v_mfma_f32_16x16x32_bf16 v[56:59], a[92:95], v[144:147], v[56:59]
    v_mfma_f32_16x16x32_bf16 v[56:59], a[96:99], v[148:151], v[56:59]
    v_mfma_f32_16x16x32_bf16 v[72:75], v[104:107], v[180:183], v[72:75]
    ds_read_b128 v[180:183], v32 offset:14464
    v_mfma_f32_16x16x32_bf16 v[52:55], a[240:243], v[116:119], v[52:55]
L_stub3:
    s_cbranch_execz L_back
    ds_read_b128 v[104:107], v32 offset:14480
    v_mfma_f32_16x16x32_bf16 v[52:55], a[244:247], v[100:103], v[52:55]
    v_mfma_f32_16x16x32_bf16 v[52:55], a[248:251], v[120:123], v[52:55]
    v_mfma_f32_16x16x32_bf16 v[52:55], a[252:255], v[144:147], v[52:55]
    v_mfma_f32_16x16x32_bf16 v[52:55], v[188:191], v[148:151], v[52:55]
    v_mfma_f32_16x16x32_bf16 v[72:75], v[108:111], v[124:127], v[72:75]
    s_waitcnt lgkmcnt(2)
    ds_read_b128 v[124:127], v33 offset:14448
    v_mfma_f32_16x16x32_bf16 v[60:63], v[232:235], v[128:131], v[60:63]
    ds_read_b128 v[108:111], v34 offset:14448
    v_mfma_f32_16x16x32_bf16 v[68:71], v[240:243], v[128:131], v[68:71]
    v_mfma_f32_16x16x32_bf16 v[64:67], v[248:251], v[128:131], v[64:67]
    ds_read_b128 v[128:131], v26 offset:6224
    v_mfma_f32_16x16x32_bf16 v[48:51], a[120:123], v[112:115], v[48:51]
    v_mfma_f32_16x16x32_bf16 v[48:51], a[124:127], v[132:135], v[48:51]
    v_mfma_f32_16x16x32_bf16 v[48:51], a[128:131], v[136:139], v[48:51]
    v_mfma_f32_16x16x32_bf16 v[48:51], a[132:135], v[140:143], v[48:51]
    v_mfma_f32_16x16x32_bf16 v[48:51], a[136:139], v[156:159], v[48:51]
    v_mfma_f32_16x16x32_bf16 v[72:75], v[164:167], v[160:163], v[72:75]
    ds_read_b64_tr_b16 v[160:161], v76 offset:28032
    v_mfma_f32_16x16x32_bf16 v[56:59], a[100:103], v[112:115], v[56:59]
    ds_read_b64_tr_b16 v[162:163], v76 offset:28800
    v_mfma_f32_16x16x32_bf16 v[56:59], a[104:107], v[132:135], v[56:59]
    ds_read_b128 v[164:167], v27 offset:6192
    v_mfma_f32_16x16x32_bf16 v[56:59], a[108:111], v[136:139], v[56:59]
    v_mfma_f32_16x16x32_bf16 v[56:59], a[112:115], v[140:143], v[56:59]
    v_mfma_f32_16x16x32_bf16 v[56:59], a[116:119], v[156:159], v[56:59]
    v_mfma_f32_16x16x32_bf16 v[72:75], v[172:175], v[168:171], v[72:75]
    ds_read_b64_tr_b16 v[168:169], v76 offset:29568
    v_mfma_f32_16x16x32_bf16 v[52:55], v[192:195], v[112:115], v[52:55]
    ds_read_b64_tr_b16 v[170:171], v76 offset:30336
    v_mfma_f32_16x16x32_bf16 v[52:55], v[196:199], v[132:135], v[52:55]
    ds_read_b128 v[172:175], v28 offset:6192
    v_mfma_f32_16x16x32_bf16 v[52:55], v[200:203], v[136:139], v[52:55]
    v_mfma_f32_16x16x32_bf16 v[52:55], v[204:207], v[140:143], v[52:55]
    v_mfma_f32_16x16x32_bf16 v[52:55], v[208:211], v[156:159], v[52:55]
    v_mfma_f32_16x16x32_bf16 v[72:75], v[96:99], v[184:187], v[72:75]
    ds_read_b64_tr_b16 v[184:185], v76 offset:31104
    v_mfma_f32_16x16x32_bf16 v[48:51], v[236:239], v[152:155], v[48:51]
    ds_read_b64_tr_b16 v[186:187], v76 offset:31872
    v_mfma_f32_16x16x32_bf16 v[56:59], v[244:247], v[152:155], v[56:59]
    ds_read_b128 v[96:99], v29 offset:0
    v_mfma_f32_16x16x32_bf16 v[52:55], v[252:255], v[152:155], v[52:55]
    ds_read_b64_tr_b16 v[152:153], v86 offset:0
    v_mfma_f32_16x16x32_bf16 v[56:59], a[120:123], v[176:179], v[56:59]
    s_waitcnt lgkmcnt(6)
    ds_read_b64_tr_b16 v[154:155], v86 offset:64
    v_mfma_f32_16x16x32_bf16 v[56:59], a[124:127], v[180:183], v[56:59]
    v_mfma_f32_16x16x32_bf16 v[56:59], a[128:131], v[104:107], v[56:59]
    v_cvt_pk_bf16_f32 v48, v48, v49
    v_cvt_pk_bf16_f32 v49, v50, v51
    v_mfma_f32_16x16x32_bf16 v[56:59], a[132:135], v[124:127], v[56:59]
    v_mfma_f32_16x16x32_bf16 v[56:59], a[136:139], v[108:111], v[56:59]
    v_mfma_f32_16x16x32_bf16 v[72:75], v[160:163], v[128:131], v[72:75]
    v_mfma_f32_16x16x32_bf16 v[52:55], v[212:215], v[176:179], v[52:55]
    v_mfma_f32_16x16x32_bf16 v[52:55], v[216:219], v[180:183], v[52:55]
    v_mfma_f32_16x16x32_bf16 v[52:55], v[220:223], v[104:107], v[52:55]
    v_mfma_f32_16x16x32_bf16 v[52:55], v[224:227], v[124:127], v[52:55]
    v_mfma_f32_16x16x32_bf16 v[52:55], v[228:231], v[108:111], v[52:55]
    s_waitcnt lgkmcnt(0)
    v_mfma_f32_16x16x32_bf16 v[72:75], v[168:171], v[164:167], v[72:75]
    v_mfma_f32_16x16x32_bf16 v[60:63], a[60:63], v[116:119], v[60:63]
    v_mfma_f32_16x16x32_bf16 v[60:63], a[64:67], v[100:103], v[60:63]
    ds_read_b128 v[128:131], v32 offset:16512
    v_cvt_pk_bf16_f32 v56, v56, v57
    v_mfma_f32_16x16x32_bf16 v[60:63], a[68:71], v[120:123], v[60:63]
L_stub4:
    s_cbranch_execz L_back
    ds_read_b128 v[160:163], v32 offset:16528
    v_cvt_pk_bf16_f32 v57, v58, v59
    v_mfma_f32_16x16x32_bf16 v[60:63], a[72:75], v[144:147], v[60:63]
    ds_read_b128 v[164:167], v32 offset:16544
    v_cvt_pk_bf16_f32 v52, v52, v53
    v_mfma_f32_16x16x32_bf16 v[60:63], a[76:79], v[148:151], v[60:63]
    ds_read_b128 v[168:171], v33 offset:16512
    v_cvt_pk_bf16_f32 v53, v54, v55
    v_mfma_f32_16x16x32_bf16 v[72:75], v[184:187], v[172:175], v[72:75]
    ds_read_b128 v[172:175], v34 offset:16512
    v_mfma_f32_16x16x32_bf16 v[68:71], a[40:43], v[116:119], v[68:71]
    v_permlane32_swap_b32 v52, v53
    v_cndmask_b32 v50, v49, v52, s[8:9]
    v_mfma_f32_16x16x32_bf16 v[68:71], a[44:47], v[100:103], v[68:71]
    v_cndmask_b32 v49, v48, v49, s[8:9]
    v_cndmask_b32 v48, v52, v48, s[8:9]
    v_mfma_f32_16x16x32_bf16 v[68:71], a[48:51], v[120:123], v[68:71]
    buffer_store_dwordx3 v[48:50], v36, s[20:23], s44 offen
    v_mfma_f32_16x16x32_bf16 v[68:71], a[52:55], v[144:147], v[68:71]
    v_cndmask_b32 v58, v57, v53, s[8:9]
    v_cndmask_b32 v57, v56, v57, s[8:9]
    v_mfma_f32_16x16x32_bf16 v[68:71], a[56:59], v[148:151], v[68:71]
    v_cndmask_b32 v56, v53, v56, s[8:9]
    v_mfma_f32_16x16x32_bf16 v[72:75], v[152:155], v[96:99], v[72:75]
    ds_read_b128 v[184:187], v35 offset:12384
    v_mfma_f32_16x16x32_bf16 v[64:67], a[200:203], v[116:119], v[64:67]
    v_mfma_f32_16x16x32_bf16 v[64:67], a[204:207], v[100:103], v[64:67]
    ds_read_b128 v[96:99], v32 offset:18576
    v_mfma_f32_16x16x32_bf16 v[64:67], a[208:211], v[120:123], v[64:67]
    ds_read_b128 v[152:155], v32 offset:18592
    v_mfma_f32_16x16x32_bf16 v[64:67], a[212:215], v[144:147], v[64:67]
    buffer_store_dwordx3 v[56:58], v36, s[20:23], s45 offen
    v_mfma_f32_16x16x32_bf16 v[64:67], a[216:219], v[148:151], v[64:67]
    ds_read_b128 v[116:119], v32 offset:18608
    v_mfma_f32_16x16x32_bf16 v[60:63], a[80:83], v[112:115], v[60:63]
    ds_write_b128 v31, v[72:75]
    v_mfma_f32_16x16x32_bf16 v[60:63], a[84:87], v[132:135], v[60:63]
    ds_read_b128 v[100:103], v33 offset:18576
    v_mfma_f32_16x16x32_bf16 v[60:63], a[88:91], v[136:139], v[60:63]
    ds_read_b128 v[120:123], v34 offset:18576
    v_mfma_f32_16x16x32_bf16 v[60:63], a[92:95], v[140:143], v[60:63]
    v_mfma_f32_16x16x32_bf16 v[60:63], a[96:99], v[156:159], v[60:63]
    v_mfma_f32_16x16x32_bf16 v[68:71], a[60:63], v[112:115], v[68:71]
    v_mfma_f32_16x16x32_bf16 v[68:71], a[64:67], v[132:135], v[68:71]
    v_mfma_f32_16x16x32_bf16 v[68:71], a[68:71], v[136:139], v[68:71]
    v_mfma_f32_16x16x32_bf16 v[68:71], a[72:75], v[140:143], v[68:71]
    s_waitcnt lgkmcnt(2)
    s_barrier
    ds_read_b128 v[88:91], v87
    v_mfma_f32_16x16x32_bf16 v[68:71], a[76:79], v[156:159], v[68:71]
    v_mfma_f32_16x16x32_bf16 v[64:67], a[220:223], v[112:115], v[64:67]
    v_mfma_f32_16x16x32_bf16 v[64:67], a[224:227], v[132:135], v[64:67]
    v_mfma_f32_16x16x32_bf16 v[64:67], a[228:231], v[136:139], v[64:67]
    v_mfma_f32_16x16x32_bf16 v[64:67], a[232:235], v[140:143], v[64:67]
    v_mfma_f32_16x16x32_bf16 v[64:67], a[236:239], v[156:159], v[64:67]
    v_mfma_f32_16x16x32_bf16 v[60:63], a[100:103], v[176:179], v[60:63]
    v_mfma_f32_16x16x32_bf16 v[60:63], a[104:107], v[180:183], v[60:63]
    s_waitcnt lgkmcnt(0)
    v_add_f32 v72, v72, v88
    v_add_f32 v73, v73, v89
    v_mfma_f32_16x16x32_bf16 v[60:63], a[108:111], v[104:107], v[60:63]
    v_add_f32 v74, v74, v90
    v_add_f32 v75, v75, v91
    v_mfma_f32_16x16x32_bf16 v[60:63], a[112:115], v[124:127], v[60:63]
    v_cvt_pk_bf16_f32 v72, v72, v73
    v_cvt_pk_bf16_f32 v73, v74, v75
    v_mfma_f32_16x16x32_bf16 v[60:63], a[116:119], v[108:111], v[60:63]
L_stub5:
    s_cbranch_execz L_back
    buffer_store_dwordx2 v[72:73], v30, s[20:23], s44 offen
    v_mfma_f32_16x16x32_bf16 v[64:67], a[240:243], v[176:179], v[64:67]
    v_mfma_f32_16x16x32_bf16 v[64:67], a[244:247], v[180:183], v[64:67]
    v_mfma_f32_16x16x32_bf16 v[64:67], a[248:251], v[104:107], v[64:67]
    v_mfma_f32_16x16x32_bf16 v[64:67], a[252:255], v[124:127], v[64:67]
    v_mfma_f32_16x16x32_bf16 v[64:67], v[188:191], v[108:111], v[64:67]
    v_mfma_f32_16x16x32_bf16 v[60:63], a[120:123], v[128:131], v[60:63]
    v_mfma_f32_16x16x32_bf16 v[60:63], a[124:127], v[160:163], v[60:63]
    v_mfma_f32_16x16x32_bf16 v[60:63], a[128:131], v[164:167], v[60:63]
    v_mfma_f32_16x16x32_bf16 v[60:63], a[132:135], v[168:171], v[60:63]
    v_mfma_f32_16x16x32_bf16 v[60:63], a[136:139], v[172:175], v[60:63]
    v_mfma_f32_16x16x32_bf16 v[64:67], v[192:195], v[128:131], v[64:67]
    v_mfma_f32_16x16x32_bf16 v[64:67], v[196:199], v[160:163], v[64:67]
    v_mfma_f32_16x16x32_bf16 v[64:67], v[200:203], v[164:167], v[64:67]
    v_mfma_f32_16x16x32_bf16 v[64:67], v[204:207], v[168:171], v[64:67]
    v_mfma_f32_16x16x32_bf16 v[64:67], v[208:211], v[172:175], v[64:67]
    v_mfma_f32_16x16x32_bf16 v[60:63], v[236:239], v[184:187], v[60:63]
    v_mfma_f32_16x16x32_bf16 v[64:67], v[252:255], v[184:187], v[64:67]
    v_mfma_f32_16x16x32_bf16 v[64:67], v[212:215], v[96:99], v[64:67]
    v_mfma_f32_16x16x32_bf16 v[64:67], v[216:219], v[152:155], v[64:67]
    v_mfma_f32_16x16x32_bf16 v[64:67], v[220:223], v[116:119], v[64:67]
    v_mfma_f32_16x16x32_bf16 v[64:67], v[224:227], v[100:103], v[64:67]
    v_mfma_f32_16x16x32_bf16 v[64:67], v[228:231], v[120:123], v[64:67]
    v_mfma_f32_16x16x32_bf16 v[68:71], a[80:83], v[176:179], v[68:71]
    v_mfma_f32_16x16x32_bf16 v[68:71], a[84:87], v[180:183], v[68:71]
    v_mfma_f32_16x16x32_bf16 v[68:71], a[88:91], v[104:107], v[68:71]
    v_mfma_f32_16x16x32_bf16 v[68:71], a[92:95], v[124:127], v[68:71]
    v_cvt_pk_bf16_f32 v60, v60, v61
    v_cvt_pk_bf16_f32 v61, v62, v63
    v_mfma_f32_16x16x32_bf16 v[68:71], a[96:99], v[108:111], v[68:71]
    v_mfma_f32_16x16x32_bf16 v[68:71], a[100:103], v[128:131], v[68:71]
    v_mfma_f32_16x16x32_bf16 v[68:71], a[104:107], v[160:163], v[68:71]
    v_mfma_f32_16x16x32_bf16 v[68:71], a[108:111], v[164:167], v[68:71]
    v_cvt_pk_bf16_f32 v64, v64, v65
    v_cvt_pk_bf16_f32 v65, v66, v67
    v_mfma_f32_16x16x32_bf16 v[68:71], a[112:115], v[168:171], v[68:71]
    v_mfma_f32_16x16x32_bf16 v[68:71], a[116:119], v[172:175], v[68:71]
    v_mfma_f32_16x16x32_bf16 v[68:71], v[244:247], v[184:187], v[68:71]
    v_permlane32_swap_b32 v64, v65
    v_cndmask_b32 v62, v61, v64, s[8:9]
    v_mfma_f32_16x16x32_bf16 v[68:71], a[120:123], v[96:99], v[68:71]
    v_cndmask_b32 v61, v60, v61, s[8:9]
    v_cndmask_b32 v60, v64, v60, s[8:9]
    v_mfma_f32_16x16x32_bf16 v[68:71], a[124:127], v[152:155], v[68:71]
    buffer_store_dwordx3 v[60:62], v36, s[20:23], s46 offen
    v_mfma_f32_16x16x32_bf16 v[68:71], a[128:131], v[116:119], v[68:71]
    v_mfma_f32_16x16x32_bf16 v[68:71], a[132:135], v[100:103], v[68:71]
    v_mfma_f32_16x16x32_bf16 v[68:71], a[136:139], v[120:123], v[68:71]
    s_nop 7
    v_cvt_pk_bf16_f32 v68, v68, v69
    v_cvt_pk_bf16_f32 v69, v70, v71
    v_cndmask_b32 v70, v69, v65, s[8:9]
    v_cndmask_b32 v69, v68, v69, s[8:9]
    v_cndmask_b32 v68, v65, v68, s[8:9]
    buffer_store_dwordx3 v[68:70], v36, s[20:23], s47 offen
L_end:
    s_endpgm
.section .rodata,"a"
.p2align 6
.amdhsa_kernel standalone__grouped__vision_kernel
  .amdhsa_next_free_vgpr 512
  .amdhsa_next_free_sgpr 102
  .amdhsa_accum_offset 256
  .amdhsa_group_segment_fixed_size 0
  .amdhsa_kernarg_size 40
  .amdhsa_user_sgpr_count 2
  .amdhsa_user_sgpr_kernarg_segment_ptr 1
  .amdhsa_system_sgpr_workgroup_id_x 1
  .amdhsa_float_denorm_mode_32 3
.end_amdhsa_kernel
```
